```python
import torch

def _softmax(x, axis=-1):
    return torch.softmax(x, dim=axis)
def _gelu(x):
    return torch.nn.functional.gelu(x, approximate="tanh")
def _silu(x):
    return torch.nn.functional.silu(x)
def _sigmoid(x):
    return torch.sigmoid(x)
def _layernorm(x, axis=-1, eps=1e-5):
    m = x.mean(dim=axis, keepdim=True)
    v = x.var(dim=axis, keepdim=True, unbiased=False)
    return (x - m) / torch.sqrt(v + eps)
def _scatter_add(tgt, idx, src, axis=0):
    return tgt.clone().index_add_(axis, idx, src)
def _segment_sum(src, seg, n):
    out = torch.zeros((n,) + src.shape[1:], dtype=src.dtype)
    return out.index_add_(0, seg, src)
def _pad(x, pw):
    flat = tuple(v for pair in reversed(pw) for v in pair)
    return torch.nn.functional.pad(x, flat)

kernel_name = 'standalone__batchnorm__sampling'

def setup_inputs():

    _w = (lambda a: (lambda t: t.to(torch.bfloat16) if t.is_floating_point() else t)(torch.as_tensor(a)))
    B, S, C = 1024, 16, 448
    K = 3
    return {
        "x": _w((lambda *s: torch.randn(*s, dtype=torch.bfloat16) * 0.05)(B, S, C)),
        "w": _w((lambda *s: torch.randn(*s, dtype=torch.bfloat16) * 0.05)(K, C, C) * (1.0 / (K * C) ** 0.5)),
        "mean": _w((lambda *s: torch.randn(*s, dtype=torch.bfloat16) * 0.05)(C) * 0.1),
        "var": _w(torch.abs((lambda *s: torch.randn(*s, dtype=torch.bfloat16) * 0.05)(C)) + 0.5),
        "g": _w((lambda *s: torch.randn(*s, dtype=torch.bfloat16) * 0.05)(C) + 1.0),
        "b": _w((lambda *s: torch.randn(*s, dtype=torch.bfloat16) * 0.05)(C) * 0.1),
    }

def reference(x, w, mean, var, g, b):
    K = 3
    P = K // 2
    S = x.shape[1]
    xp = _pad(x, ((0, 0), (P, P), (0, 0)))
    y = sum(torch.einsum('bsc,cd->bsd', xp[:, k:k + S, :], w[k]) for k in range(K))
    inv_std = 1.0 / torch.sqrt(var + 1e-5)
    y = (y - mean) * (g * inv_std) + b
    return _silu(y)
```

```asm
; @launch grid=(256,1,1) block=(256,1,1) lds=163840
.amdgcn_target "amdgcn-amd-amdhsa--gfx950"
.text
.globl standalone__batchnorm__sampling_kernel
.p2align 12
.p2align 8
.type standalone__batchnorm__sampling_kernel,@function
standalone__batchnorm__sampling_kernel:
 s_load_dwordx2 s[24:25], s[0:1], 8
 s_load_dwordx2 s[20:21], s[0:1], 0
 s_load_dwordx4 s[8:11], s[0:1], 16
 s_load_dwordx4 s[12:15], s[0:1], 32
 s_load_dwordx4 s[16:19], s[0:1], 48
 s_cmp_ge_u32 s2, 256
 s_cbranch_scc1 L_end0
 s_getpc_b64 s[64:65]
L_pf:
 s_and_b32 s54, s2, 0xf8
 v_add_u32 v25, s54, v0
 s_mov_b32 s66, L_end-L_pf
 v_lshlrev_b32 v25, 7, v25
 v_lshrrev_b32 v26, 3, v0
 s_mov_b32 s67, 0x20000
 v_lshl_add_u32 v25, v26, 20, v25
 buffer_load_dword v26, v25, s[64:67], 0 offen
 s_and_b32 s40, s2, 7
 s_lshr_b32 s41, s2, 3
 s_lshr_b32 s42, s40, 1
 s_and_b32 s43, s40, 1
 s_mul_i32 s44, s41, 37
 s_lshr_b32 s44, s44, 8
 s_mul_i32 s45, s44, 7
 s_sub_u32 s45, s41, s45
 s_lshl_b32 s46, s43, 2
 s_sub_u32 s47, 29, s43
 s_mul_i32 s47, s47, s44
 s_mul_i32 s48, s43, 116
 s_add_u32 s47, s47, s48
 s_cmp_ge_u32 s41, 28
 s_cselect_b32 s48, s46, 0
 s_cselect_b32 s47, 228, s47
 s_cselect_b32 s43, 1, s43
 s_add_u32 s45, s45, s48
 s_cmp_ge_u32 s45, 7
 s_cbranch_scc0 L_go
L_end0:
 s_endpgm
L_go:
 s_lshl_b32 s42, s42, 8
 s_add_u32 s47, s47, s42
 v_lshrrev_b32 v33, 6, v0
 v_and_b32 v28, 63, v0
 s_lshl_b32 s50, s45, 7
 v_readfirstlane_b32 s49, v33
 s_mul_i32 s51, s47, 14336
 v_lshrrev_b32 v29, 3, v28
 v_and_b32 v30, 7, v28
 s_lshl_b32 s52, s49, 10
 s_mul_i32 s53, s49, 7168
 v_mul_u32_u24 v31, 896, v29
 v_add_u32 v31, s53, v31
 v_and_b32 v32, 6, v29
 v_xor_b32 v32, v32, v30
 v_lshl_add_u32 v1, v32, 4, v31
 v_add_u32 v31, s50, v31
 v_and_b32 v32, 2, v29
 s_and_b32 s54, s49, 1
 s_lshl_b32 s54, s54, 2
 v_or_b32 v32, s54, v32
 v_xor_b32 v32, v32, v30
 v_lshl_add_u32 v2, v32, 4, v31
 s_and_b32 s57, s45, 7
 s_mul_i32 s57, s57, 6
 s_and_b32 s55, s40, 6
 s_mul_i32 s55, s55, 1
 s_add_u32 s57, s57, s55
 s_mul_i32 s55, s57, 9363
 s_lshr_b32 s55, s55, 16
 s_mul_i32 s55, s55, 7
 s_sub_u32 s57, s57, s55
 s_mul_i32 s68, s57, 57344
 s_lshl_b32 s55, s57, 7
 s_add_u32 s36, s55, s51
 v_add_u32 v240, s36, v1
 v_add_u32 v248, s68, v2
 s_add_u32 s57, s57, 1
 s_cmp_eq_u32 s57, 7
 s_cselect_b32 s57, 0, s57
 s_mul_i32 s69, s57, 57344
 s_lshl_b32 s55, s57, 7
 s_add_u32 s37, s55, s51
 v_add_u32 v241, s37, v1
 v_add_u32 v249, s69, v2
 s_add_u32 s57, s57, 1
 s_cmp_eq_u32 s57, 7
 s_cselect_b32 s57, 0, s57
 s_mov_b32 s26, 1204224
 s_mov_b32 s27, 0x20000
 s_mov_b32 s22, 14680064
 s_mov_b32 s23, 0x20000
 s_add_u32 m0, s52, 0
 s_add_u32 s60, s68, 0
 s_waitcnt lgkmcnt(0)
 buffer_load_dwordx4 v2, s[24:27], s60 offen lds
 s_add_u32 m0, s52, 4096
 s_add_u32 s60, s68, 28672
 buffer_load_dwordx4 v2, s[24:27], s60 offen lds
 s_lshl_b32 s46, s49, 5
 s_add_u32 s46, s46, s50
 s_load_dword s47, s[8:9], s46
 s_load_dword s48, s[10:11], s46
 s_load_dword s40, s[12:13], s46
 s_load_dword s42, s[14:15], s46
 s_add_u32 m0, s52, 8192
 s_add_u32 s60, s68, 430080
 buffer_load_dwordx4 v2, s[24:27], s60 offen lds
 s_add_u32 m0, s52, 12288
 s_add_u32 s60, s68, 401408
 buffer_load_dwordx4 v2, s[24:27], s60 offen lds
 s_add_u32 m0, s52, 16384
 s_add_u32 s60, s68, 802816
 buffer_load_dwordx4 v2, s[24:27], s60 offen lds
 s_add_u32 m0, s52, 20480
 s_add_u32 s60, s68, 831488
 buffer_load_dwordx4 v2, s[24:27], s60 offen lds
 s_add_u32 m0, s52, 24576
 s_add_u32 s60, s36, 0
 buffer_load_dwordx4 v1, s[20:23], s60 offen lds
 v_lshrrev_b32 v34, 4, v28
 s_lshl_b32 s54, s49, 5
 s_add_u32 s54, s54, s50
 v_lshlrev_b32 v35, 3, v34
 v_add_u32 v35, s54, v35
 s_mov_b32 s34, 896
 s_mov_b32 s35, 0x20000
 v_mov_b32 v52, s8
 v_mov_b32 v53, s9
 s_mov_b32 exec_lo, 0x22222222
 s_mov_b32 exec_hi, 0x22222222
 v_mov_b32 v52, s10
 v_mov_b32 v53, s11
 s_mov_b32 exec_lo, 0x44444444
 s_mov_b32 exec_hi, 0x44444444
 v_mov_b32 v52, s12
 v_mov_b32 v53, s13
 s_mov_b32 exec_lo, 0x88888888
 s_mov_b32 exec_hi, 0x88888888
 v_mov_b32 v52, s14
 v_mov_b32 v53, s15
 s_mov_b64 exec, -1
 v_add_co_u32 v52, vcc, v52, v35
 s_nop 1
 v_addc_co_u32 v53, vcc, 0, v53, vcc
 s_mul_i32 s70, s57, 57344
 s_lshl_b32 s55, s57, 7
 s_add_u32 s38, s55, s51
 v_add_u32 v242, s38, v1
 v_add_u32 v250, s70, v2
 s_add_u32 s57, s57, 1
 s_cmp_eq_u32 s57, 7
 s_cselect_b32 s57, 0, s57
 s_mul_i32 s71, s57, 57344
 s_lshl_b32 s55, s57, 7
 s_add_u32 s39, s55, s51
 v_add_u32 v243, s39, v1
 v_add_u32 v251, s71, v2
 s_add_u32 s57, s57, 1
 s_cmp_eq_u32 s57, 7
 s_cselect_b32 s57, 0, s57
 s_mul_i32 s72, s57, 57344
 s_lshl_b32 s55, s57, 7
 s_add_u32 s62, s55, s51
 v_add_u32 v244, s62, v1
 v_add_u32 v252, s72, v2
 s_add_u32 s57, s57, 1
 s_cmp_eq_u32 s57, 7
 s_cselect_b32 s57, 0, s57
 s_mul_i32 s73, s57, 57344
 s_lshl_b32 s55, s57, 7
 s_add_u32 s63, s55, s51
 v_add_u32 v245, s63, v1
 v_add_u32 v253, s73, v2
 s_add_u32 s57, s57, 1
 s_cmp_eq_u32 s57, 7
 s_cselect_b32 s57, 0, s57
 s_mul_i32 s74, s57, 57344
 s_lshl_b32 s55, s57, 7
 s_add_u32 s75, s55, s51
 v_add_u32 v246, s75, v1
 v_add_u32 v254, s74, v2
 s_add_u32 m0, s52, 28672
 s_add_u32 s60, s36, 28672
 buffer_load_dwordx4 v1, s[20:23], s60 offen lds
 s_add_u32 m0, s52, 32768
 s_add_u32 s60, s36, 57344
 buffer_load_dwordx4 v1, s[20:23], s60 offen lds
 s_add_u32 m0, s52, 36864
 s_add_u32 s60, s69, 0
 buffer_load_dwordx4 v2, s[24:27], s60 offen lds
 s_add_u32 m0, s52, 40960
 s_add_u32 s60, s69, 28672
 buffer_load_dwordx4 v2, s[24:27], s60 offen lds
 s_mov_b64 exec, 0
 s_cmp_eq_u32 s49, 0
 s_cbranch_scc1 L_pad1
 s_cmp_eq_u32 s49, 1
 s_cbranch_scc1 L_pad2
 s_cmp_eq_u32 s49, 2
 s_cbranch_scc1 L_pad3
 s_cmp_eq_u32 s49, 3
 s_cbranch_scc1 L_pad4
L_hopdone1:
 s_mov_b64 exec, -1
 s_add_u32 m0, s52, 45056
 s_add_u32 s60, s36, 86016
 buffer_load_dwordx4 v1, s[20:23], s60 offen lds
 s_add_u32 m0, s52, 49152
 s_add_u32 s60, s69, 430080
 buffer_load_dwordx4 v2, s[24:27], s60 offen lds
 s_add_u32 m0, s52, 53248
 s_add_u32 s60, s69, 401408
 buffer_load_dwordx4 v2, s[24:27], s60 offen lds
 s_add_u32 m0, s52, 57344
 s_add_u32 s60, s36, 114688
 buffer_load_dwordx4 v1, s[20:23], s60 offen lds
 s_add_u32 m0, s52, 61440
 s_add_u32 s60, s69, 802816
 buffer_load_dwordx4 v2, s[24:27], s60 offen lds
 s_add_u32 m0, s52, 65536
 s_add_u32 s60, s69, 831488
 buffer_load_dwordx4 v2, s[24:27], s60 offen lds
 v_xor_b32 v32, v30, v29
 v_lshl_add_u32 v3, v32, 4, v31
 s_lshl_b32 s55, s43, 30
 s_add_u32 s55, s55, 401408
 s_cmp_lt_u32 s49, 2
 s_cselect_b32 s4, s36, s37
 s_cselect_b32 s5, s38, s39
 s_cselect_b32 s6, s62, s63
 s_cselect_b32 s7, s75, 0x40000000
 s_cselect_b32 s54, 0, 14336
 s_sub_u32 s55, s55, s54
 s_add_u32 s4, s4, s55
 s_add_u32 s5, s5, s55
 s_add_u32 s6, s6, s55
 s_add_u32 s7, s7, s55
 s_lshr_b32 s56, s49, 1
 s_lshl_b32 s56, s56, 30
 s_add_u32 s56, s56, s51
 s_mov_b32 s53, 0xbfb8aa3b
 s_mov_b32 s28, s16
 s_mov_b32 s29, s17
 s_mov_b32 s30, 14680064
 s_mov_b32 s31, 0x20000
 v_and_b32 v33, 15, v28
 v_and_b32 v36, 7, v33
 v_lshrrev_b32 v37, 3, v33
 v_and_b32 v32, 6, v36
 v_xor_b32 v32, v32, v34
 v_lshlrev_b32 v4, 10, v37
 v_lshl_add_u32 v4, v36, 7, v4
 v_lshl_add_u32 v4, v32, 4, v4
 v_xor_b32 v5, 64, v4
 v_add_u32 v6, 0x10000, v4
 v_add_u32 v7, 0x10000, v5
 v_add_u32 v8, 0x20000, v4
 v_add_u32 v9, 0x20000, v5
 v_lshrrev_b32 v38, 2, v33
 v_and_b32 v39, 3, v33
 v_lshrrev_b32 v32, 1, v39
 s_lshl_b32 s54, s49, 1
 v_add_u32 v32, s54, v32
 v_and_b32 v40, 2, v38
 v_and_b32 v41, 1, v34
 v_lshl_or_b32 v40, v41, 2, v40
 v_xor_b32 v32, v32, v40
 v_lshlrev_b32 v10, 10, v34
 v_lshl_add_u32 v10, v38, 7, v10
 v_lshl_add_u32 v10, v32, 4, v10
 v_and_b32 v39, 1, v39
 v_lshl_add_u32 v10, v39, 3, v10
 v_add_u32 v11, 0x10000, v10
 v_add_u32 v12, 0x20000, v10
 v_lshrrev_b32 v32, 1, v34
 v_add_u32 v32, s54, v32
 v_xor_b32 v32, v32, v36
 v_lshlrev_b32 v13, 7, v33
 v_lshl_add_u32 v13, v32, 4, v13
 v_lshl_add_u32 v13, v41, 3, v13
 v_add_u32 v13, 147456, v13
 v_lshlrev_b32 v14, 4, v0
 v_add_u32 v14, 147456, v14
 v_mul_u32_u24 v15, 896, v33
 v_add_u32 v15, v35, v15
 s_add_u32 s16, s24, 28672
 s_addc_u32 s17, s25, 0
 s_add_u32 s70, s24, 401408
 s_addc_u32 s71, s25, 0
 s_add_u32 s72, s24, 430080
 s_addc_u32 s73, s25, 0
 s_add_u32 s74, s24, 802816
 s_addc_u32 s75, s25, 0
 s_add_u32 s62, s24, 831488
 s_addc_u32 s63, s25, 0
 s_add_u32 s8, s20, 28672
 s_addc_u32 s9, s21, 0
 s_add_u32 s10, s20, 57344
 s_addc_u32 s11, s21, 0
 s_add_u32 s12, s20, 86016
 s_addc_u32 s13, s21, 0
 s_add_u32 s14, s20, 114688
 s_addc_u32 s15, s21, 0
 s_waitcnt vmcnt(10) lgkmcnt(0)
 s_barrier
 ds_read_b64_tr_b16 a[0:1], v10 offset:0
 ds_read_b64_tr_b16 a[2:3], v10 offset:512
 ds_read_b128 a[168:171], v4 offset:24576
 ds_read_b64_tr_b16 a[4:5], v10 offset:4096
 ds_read_b64_tr_b16 a[6:7], v10 offset:4608
 ds_read_b128 a[172:175], v5 offset:24576
 ds_read_b64_tr_b16 a[60:61], v10 offset:8192
 ds_read_b64_tr_b16 a[62:63], v10 offset:8704
 ds_read_b64_tr_b16 a[56:57], v10 offset:12288
 ds_read_b64_tr_b16 a[58:59], v10 offset:12800
 ds_read_b64_tr_b16 a[112:113], v10 offset:16384
 ds_read_b64_tr_b16 a[114:115], v10 offset:16896
 ds_read_b64_tr_b16 a[116:117], v10 offset:20480
 ds_read_b64_tr_b16 a[118:119], v10 offset:20992
 ds_read_b128 a[176:179], v4 offset:26624
 ds_read_b128 a[180:183], v5 offset:26624
 s_waitcnt lgkmcnt(13)
 v_mfma_f32_16x16x32_bf16 v[64:67], a[0:3], a[168:171], 0
 s_waitcnt vmcnt(9) lgkmcnt(10)
 v_mfma_f32_16x16x32_bf16 v[64:67], a[4:7], a[172:175], v[64:67]
 s_waitcnt lgkmcnt(8)
 s_barrier
 v_mfma_f32_16x16x32_bf16 v[68:71], a[60:63], a[172:175], 0
 s_waitcnt lgkmcnt(6)
 ds_read_b128 a[184:187], v4 offset:28672
 v_mfma_f32_16x16x32_bf16 v[68:71], a[56:59], a[168:171], v[68:71]
 s_waitcnt lgkmcnt(5)
 ds_read_b128 a[188:191], v5 offset:28672
 v_mfma_f32_16x16x32_bf16 v[72:75], a[112:115], a[168:171], 0
 s_waitcnt lgkmcnt(2)
 ds_read_b128 a[196:199], v5 offset:30720
 v_mfma_f32_16x16x32_bf16 v[72:75], a[116:119], a[172:175], v[72:75]
 s_add_u32 m0, s52, 69632
 ds_read_b128 a[192:195], v4 offset:30720
 v_mfma_f32_16x16x32_bf16 v[84:87], a[116:119], a[180:183], 0
 global_load_lds_dwordx4 v241, s[20:21]
 v_mfma_f32_16x16x32_bf16 v[84:87], a[112:115], a[176:179], v[84:87]
 s_add_u32 m0, s52, 73728
 v_mfma_f32_16x16x32_bf16 v[80:83], a[56:59], a[176:179], 0
 v_mfma_f32_16x16x32_bf16 v[80:83], a[60:63], a[180:183], v[80:83]
 global_load_lds_dwordx4 v250, s[24:25]
 v_mfma_f32_16x16x32_bf16 v[76:79], a[4:7], a[180:183], 0
 s_add_u32 m0, s52, 77824
 v_mfma_f32_16x16x32_bf16 v[76:79], a[0:3], a[176:179], v[76:79]
 s_waitcnt lgkmcnt(1)
 v_mfma_f32_16x16x32_bf16 v[88:91], a[0:3], a[184:187], 0
 s_waitcnt vmcnt(10)
 v_mfma_f32_16x16x32_bf16 v[88:91], a[4:7], a[188:191], v[88:91]
 s_barrier
 v_mfma_f32_16x16x32_bf16 v[92:95], a[60:63], a[188:191], 0
 global_load_lds_dwordx4 v250, s[16:17]
 v_mfma_f32_16x16x32_bf16 v[92:95], a[56:59], a[184:187], v[92:95]
 s_add_u32 m0, s52, 81920
 ds_read_b128 a[168:171], v4 offset:32768
 v_mfma_f32_16x16x32_bf16 v[96:99], a[112:115], a[184:187], 0
 ds_read_b128 a[172:175], v5 offset:32768
 v_mfma_f32_16x16x32_bf16 v[96:99], a[116:119], a[188:191], v[96:99]
 s_waitcnt lgkmcnt(2)
 ds_read_b128 a[180:183], v5 offset:34816
 v_mfma_f32_16x16x32_bf16 v[108:111], a[116:119], a[196:199], 0
 global_load_lds_dwordx4 v241, s[8:9]
 v_mfma_f32_16x16x32_bf16 v[108:111], a[112:115], a[192:195], v[108:111]
 s_add_u32 m0, s52, 86016
 ds_read_b128 a[176:179], v4 offset:34816
 v_mfma_f32_16x16x32_bf16 v[104:107], a[56:59], a[192:195], 0
 v_mfma_f32_16x16x32_bf16 v[104:107], a[60:63], a[196:199], v[104:107]
 global_load_lds_dwordx4 v250, s[72:73]
 v_mfma_f32_16x16x32_bf16 v[100:103], a[4:7], a[196:199], 0
 s_add_u32 m0, s52, 90112
 v_mfma_f32_16x16x32_bf16 v[100:103], a[0:3], a[192:195], v[100:103]
 s_waitcnt lgkmcnt(1)
 v_mfma_f32_16x16x32_bf16 v[112:115], a[0:3], a[168:171], 0
 s_waitcnt vmcnt(10)
 v_mfma_f32_16x16x32_bf16 v[112:115], a[4:7], a[172:175], v[112:115]
 s_barrier
 v_mfma_f32_16x16x32_bf16 v[116:119], a[60:63], a[172:175], 0
 global_load_lds_dwordx4 v241, s[10:11]
 v_mfma_f32_16x16x32_bf16 v[116:119], a[56:59], a[168:171], v[116:119]
 s_add_u32 m0, s52, 94208
 ds_read_b128 a[184:187], v4 offset:45056
 v_mfma_f32_16x16x32_bf16 v[120:123], a[112:115], a[168:171], 0
 ds_read_b128 a[188:191], v5 offset:45056
 v_mfma_f32_16x16x32_bf16 v[120:123], a[116:119], a[172:175], v[120:123]
 s_waitcnt lgkmcnt(2)
 ds_read_b128 a[196:199], v5 offset:47104
 v_mfma_f32_16x16x32_bf16 v[132:135], a[116:119], a[180:183], 0
 global_load_lds_dwordx4 v250, s[70:71]
 v_mfma_f32_16x16x32_bf16 v[132:135], a[112:115], a[176:179], v[132:135]
 s_add_u32 m0, s52, 98304
 ds_read_b128 a[192:195], v4 offset:47104
 v_mfma_f32_16x16x32_bf16 v[128:131], a[56:59], a[176:179], 0
 ds_read_b64_tr_b16 a[8:9], v10 offset:36864
 v_mfma_f32_16x16x32_bf16 v[128:131], a[60:63], a[180:183], v[128:131]
 global_load_lds_dwordx4 v241, s[12:13]
 v_mfma_f32_16x16x32_bf16 v[124:127], a[4:7], a[180:183], 0
 s_add_u32 m0, s52, 102400
 ds_read_b64_tr_b16 a[10:11], v10 offset:37376
 v_mfma_f32_16x16x32_bf16 v[124:127], a[0:3], a[176:179], v[124:127]
 s_waitcnt lgkmcnt(3)
 ds_read_b64_tr_b16 a[12:13], v10 offset:40960
 v_mfma_f32_16x16x32_bf16 v[136:139], a[0:3], a[184:187], 0
 s_waitcnt vmcnt(10)
 ds_read_b64_tr_b16 a[14:15], v10 offset:41472
 v_mfma_f32_16x16x32_bf16 v[136:139], a[4:7], a[188:191], v[136:139]
 s_barrier
 v_mfma_f32_16x16x32_bf16 v[140:143], a[60:63], a[188:191], 0
 global_load_lds_dwordx4 v250, s[74:75]
 v_mfma_f32_16x16x32_bf16 v[140:143], a[56:59], a[184:187], v[140:143]
 s_add_u32 m0, s52, 106496
 ds_read_b128 a[168:171], v4 offset:57344
 v_mfma_f32_16x16x32_bf16 v[144:147], a[112:115], a[184:187], 0
 ds_read_b128 a[172:175], v5 offset:57344
 v_mfma_f32_16x16x32_bf16 v[144:147], a[116:119], a[188:191], v[144:147]
 s_waitcnt lgkmcnt(6)
 ds_read_b128 a[180:183], v5 offset:59392
 v_mfma_f32_16x16x32_bf16 v[156:159], a[116:119], a[196:199], 0
 global_load_lds_dwordx4 v241, s[14:15]
 v_mfma_f32_16x16x32_bf16 v[156:159], a[112:115], a[192:195], v[156:159]
 s_add_u32 m0, s52, 110592
 ds_read_b128 a[176:179], v4 offset:59392
 v_mfma_f32_16x16x32_bf16 v[152:155], a[56:59], a[192:195], 0
 ds_read_b64_tr_b16 a[68:69], v10 offset:49152
 v_mfma_f32_16x16x32_bf16 v[152:155], a[60:63], a[196:199], v[152:155]
 global_load_lds_dwordx4 v250, s[62:63]
 v_mfma_f32_16x16x32_bf16 v[148:151], a[4:7], a[196:199], 0
 s_add_u32 m0, s52, 114688
 ds_read_b64_tr_b16 a[70:71], v10 offset:49664
 v_mfma_f32_16x16x32_bf16 v[148:151], a[0:3], a[192:195], v[148:151]
 s_waitcnt lgkmcnt(3)
 ds_read_b64_tr_b16 a[64:65], v10 offset:53248
 v_mfma_f32_16x16x32_bf16 v[160:163], a[0:3], a[168:171], 0
 s_waitcnt vmcnt(10)
 ds_read_b64_tr_b16 a[66:67], v10 offset:53760
 v_mfma_f32_16x16x32_bf16 v[160:163], a[4:7], a[172:175], v[160:163]
 s_barrier
 v_mfma_f32_16x16x32_bf16 v[164:167], a[60:63], a[172:175], 0
 global_load_lds_dwordx4 v242, s[20:21]
 v_mfma_f32_16x16x32_bf16 v[164:167], a[56:59], a[168:171], v[164:167]
 s_add_u32 m0, s52, 118784
 ds_read_b128 a[184:187], v6 offset:4096
 v_mfma_f32_16x16x32_bf16 v[168:171], a[112:115], a[168:171], 0
 ds_read_b128 a[188:191], v7 offset:4096
 v_mfma_f32_16x16x32_bf16 v[168:171], a[116:119], a[172:175], v[168:171]
 s_waitcnt lgkmcnt(6)
 ds_read_b64_tr_b16 a[120:121], v10 offset:61440
 v_mfma_f32_16x16x32_bf16 v[180:183], a[116:119], a[180:183], 0
 global_load_lds_dwordx4 v251, s[24:25]
 v_mfma_f32_16x16x32_bf16 v[180:183], a[112:115], a[176:179], v[180:183]
 s_add_u32 m0, s52, 122880
 ds_read_b64_tr_b16 a[122:123], v10 offset:61952
 ds_read_b64_tr_b16 a[124:125], v11 offset:0
 v_mfma_f32_16x16x32_bf16 v[176:179], a[56:59], a[176:179], 0
 ds_read_b64_tr_b16 a[126:127], v11 offset:512
 v_mfma_f32_16x16x32_bf16 v[176:179], a[60:63], a[180:183], v[176:179]
 global_load_lds_dwordx4 v251, s[16:17]
 v_mfma_f32_16x16x32_bf16 v[172:175], a[4:7], a[180:183], 0
 s_add_u32 m0, s52, 126976
 ds_read_b128 a[196:199], v7 offset:6144
 v_mfma_f32_16x16x32_bf16 v[172:175], a[0:3], a[176:179], v[172:175]
 s_waitcnt lgkmcnt(5)
 ds_read_b128 a[192:195], v6 offset:6144
 v_mfma_f32_16x16x32_bf16 v[64:67], a[8:11], a[184:187], v[64:67]
 s_waitcnt vmcnt(10)
 v_mfma_f32_16x16x32_bf16 v[64:67], a[12:15], a[188:191], v[64:67]
 s_barrier
 v_mfma_f32_16x16x32_bf16 v[68:71], a[68:71], a[188:191], v[68:71]
 s_waitcnt lgkmcnt(2)
 ds_read_b128 a[168:171], v6 offset:16384
 v_mfma_f32_16x16x32_bf16 v[68:71], a[64:67], a[184:187], v[68:71]
 global_load_lds_dwordx4 v242, s[8:9]
 v_mfma_f32_16x16x32_bf16 v[72:75], a[120:123], a[184:187], v[72:75]
 s_add_u32 m0, s52, 131072
 ds_read_b128 a[172:175], v7 offset:16384
 v_mfma_f32_16x16x32_bf16 v[72:75], a[124:127], a[188:191], v[72:75]
 s_waitcnt lgkmcnt(2)
 ds_read_b128 a[180:183], v7 offset:18432
 v_mfma_f32_16x16x32_bf16 v[84:87], a[124:127], a[196:199], v[84:87]
 global_load_lds_dwordx4 v251, s[72:73]
 v_mfma_f32_16x16x32_bf16 v[84:87], a[120:123], a[192:195], v[84:87]
 s_add_u32 m0, s52, 135168
 ds_read_b128 a[176:179], v6 offset:18432
 v_mfma_f32_16x16x32_bf16 v[80:83], a[64:67], a[192:195], v[80:83]
 ds_read_b64_tr_b16 a[16:17], v11 offset:8192
 v_mfma_f32_16x16x32_bf16 v[80:83], a[68:71], a[196:199], v[80:83]
 global_load_lds_dwordx4 v242, s[10:11]
 v_mfma_f32_16x16x32_bf16 v[76:79], a[12:15], a[196:199], v[76:79]
 s_add_u32 m0, s52, 139264
 ds_read_b64_tr_b16 a[18:19], v11 offset:8704
 v_mfma_f32_16x16x32_bf16 v[76:79], a[8:11], a[192:195], v[76:79]
 s_waitcnt lgkmcnt(3)
 ds_read_b64_tr_b16 a[20:21], v11 offset:12288
 v_mfma_f32_16x16x32_bf16 v[88:91], a[8:11], a[168:171], v[88:91]
 s_waitcnt vmcnt(11)
 ds_read_b64_tr_b16 a[22:23], v11 offset:12800
 v_mfma_f32_16x16x32_bf16 v[88:91], a[12:15], a[172:175], v[88:91]
 s_barrier
 v_mfma_f32_16x16x32_bf16 v[92:95], a[68:71], a[172:175], v[92:95]
 global_load_lds_dwordx4 v251, s[70:71]
 v_mfma_f32_16x16x32_bf16 v[92:95], a[64:67], a[168:171], v[92:95]
 s_add_u32 m0, s52, 143360
 ds_read_b128 a[184:187], v6 offset:24576
 v_mfma_f32_16x16x32_bf16 v[96:99], a[120:123], a[168:171], v[96:99]
 ds_read_b128 a[188:191], v7 offset:24576
 v_mfma_f32_16x16x32_bf16 v[96:99], a[124:127], a[172:175], v[96:99]
 s_waitcnt lgkmcnt(6)
 ds_read_b128 a[196:199], v7 offset:26624
 v_mfma_f32_16x16x32_bf16 v[108:111], a[124:127], a[180:183], v[108:111]
 global_load_lds_dwordx4 v242, s[12:13]
 v_mfma_f32_16x16x32_bf16 v[108:111], a[120:123], a[176:179], v[108:111]
 s_add_u32 m0, s52, 0
 ds_read_b128 a[192:195], v6 offset:26624
 v_mfma_f32_16x16x32_bf16 v[104:107], a[64:67], a[176:179], v[104:107]
 ds_read_b64_tr_b16 a[76:77], v11 offset:20480
 v_mfma_f32_16x16x32_bf16 v[104:107], a[68:71], a[180:183], v[104:107]
 global_load_lds_dwordx4 v251, s[74:75]
 v_mfma_f32_16x16x32_bf16 v[100:103], a[12:15], a[180:183], v[100:103]
 s_add_u32 m0, s52, 4096
 ds_read_b64_tr_b16 a[78:79], v11 offset:20992
 v_mfma_f32_16x16x32_bf16 v[100:103], a[8:11], a[176:179], v[100:103]
 s_waitcnt lgkmcnt(3)
 v_mfma_f32_16x16x32_bf16 v[112:115], a[8:11], a[184:187], v[112:115]
 s_waitcnt vmcnt(12)
 v_mfma_f32_16x16x32_bf16 v[112:115], a[12:15], a[188:191], v[112:115]
 s_barrier
 v_mfma_f32_16x16x32_bf16 v[116:119], a[68:71], a[188:191], v[116:119]
 global_load_lds_dwordx4 v242, s[14:15]
 v_mfma_f32_16x16x32_bf16 v[116:119], a[64:67], a[184:187], v[116:119]
L_pad1:
 s_cbranch_execz L_pad5
 s_add_u32 m0, s52, 8192
 ds_read_b128 a[168:171], v6 offset:32768
 v_mfma_f32_16x16x32_bf16 v[120:123], a[120:123], a[184:187], v[120:123]
 ds_read_b128 a[172:175], v7 offset:32768
 v_mfma_f32_16x16x32_bf16 v[120:123], a[124:127], a[188:191], v[120:123]
 s_waitcnt lgkmcnt(4)
 ds_read_b128 a[180:183], v7 offset:34816
 v_mfma_f32_16x16x32_bf16 v[132:135], a[124:127], a[196:199], v[132:135]
 global_load_lds_dwordx4 v251, s[62:63]
 v_mfma_f32_16x16x32_bf16 v[132:135], a[120:123], a[192:195], v[132:135]
 s_add_u32 m0, s52, 12288
 ds_read_b128 a[176:179], v6 offset:34816
 v_mfma_f32_16x16x32_bf16 v[128:131], a[64:67], a[192:195], v[128:131]
 ds_read_b64_tr_b16 a[72:73], v11 offset:28672
 v_mfma_f32_16x16x32_bf16 v[128:131], a[68:71], a[196:199], v[128:131]
 ds_read_b64_tr_b16 a[74:75], v11 offset:29184
 v_mfma_f32_16x16x32_bf16 v[124:127], a[12:15], a[196:199], v[124:127]
 v_mfma_f32_16x16x32_bf16 v[124:127], a[8:11], a[192:195], v[124:127]
 s_waitcnt lgkmcnt(3)
 v_mfma_f32_16x16x32_bf16 v[136:139], a[8:11], a[168:171], v[136:139]
 s_waitcnt vmcnt(12)
 v_mfma_f32_16x16x32_bf16 v[136:139], a[12:15], a[172:175], v[136:139]
 s_barrier
 v_mfma_f32_16x16x32_bf16 v[140:143], a[68:71], a[172:175], v[140:143]
 global_load_lds_dwordx4 v243, s[20:21]
 v_mfma_f32_16x16x32_bf16 v[140:143], a[64:67], a[168:171], v[140:143]
 s_add_u32 m0, s52, 16384
 ds_read_b128 a[184:187], v6 offset:40960
 v_mfma_f32_16x16x32_bf16 v[144:147], a[120:123], a[168:171], v[144:147]
 ds_read_b128 a[188:191], v7 offset:40960
 v_mfma_f32_16x16x32_bf16 v[144:147], a[124:127], a[172:175], v[144:147]
 s_waitcnt lgkmcnt(4)
 ds_read_b128 a[196:199], v7 offset:43008
 v_mfma_f32_16x16x32_bf16 v[156:159], a[124:127], a[180:183], v[156:159]
 global_load_lds_dwordx4 v252, s[24:25]
 v_mfma_f32_16x16x32_bf16 v[156:159], a[120:123], a[176:179], v[156:159]
 s_add_u32 m0, s52, 20480
 ds_read_b128 a[192:195], v6 offset:43008
 v_mfma_f32_16x16x32_bf16 v[152:155], a[64:67], a[176:179], v[152:155]
 ds_read_b64_tr_b16 a[128:129], v11 offset:36864
 v_mfma_f32_16x16x32_bf16 v[152:155], a[68:71], a[180:183], v[152:155]
 ds_read_b64_tr_b16 a[130:131], v11 offset:37376
 v_mfma_f32_16x16x32_bf16 v[148:151], a[12:15], a[180:183], v[148:151]
 v_mfma_f32_16x16x32_bf16 v[148:151], a[8:11], a[176:179], v[148:151]
 s_waitcnt lgkmcnt(3)
 v_mfma_f32_16x16x32_bf16 v[160:163], a[8:11], a[184:187], v[160:163]
 s_waitcnt vmcnt(12)
 v_mfma_f32_16x16x32_bf16 v[160:163], a[12:15], a[188:191], v[160:163]
 s_barrier
 v_mfma_f32_16x16x32_bf16 v[164:167], a[68:71], a[188:191], v[164:167]
 global_load_lds_dwordx4 v252, s[16:17]
 v_mfma_f32_16x16x32_bf16 v[164:167], a[64:67], a[184:187], v[164:167]
 s_add_u32 m0, s52, 24576
 ds_read_b128 a[168:171], v6 offset:49152
 v_mfma_f32_16x16x32_bf16 v[168:171], a[120:123], a[184:187], v[168:171]
 ds_read_b128 a[172:175], v7 offset:49152
 v_mfma_f32_16x16x32_bf16 v[168:171], a[124:127], a[188:191], v[168:171]
 s_waitcnt lgkmcnt(4)
 ds_read_b64_tr_b16 a[132:133], v11 offset:45056
 v_mfma_f32_16x16x32_bf16 v[180:183], a[124:127], a[196:199], v[180:183]
 global_load_lds_dwordx4 v243, s[8:9]
 v_mfma_f32_16x16x32_bf16 v[180:183], a[120:123], a[192:195], v[180:183]
 s_add_u32 m0, s52, 28672
 ds_read_b64_tr_b16 a[134:135], v11 offset:45568
 v_mfma_f32_16x16x32_bf16 v[176:179], a[64:67], a[192:195], v[176:179]
 ds_read_b128 a[180:183], v7 offset:51200
 v_mfma_f32_16x16x32_bf16 v[176:179], a[68:71], a[196:199], v[176:179]
 ds_read_b128 a[176:179], v6 offset:51200
 v_mfma_f32_16x16x32_bf16 v[172:175], a[12:15], a[196:199], v[172:175]
 v_mfma_f32_16x16x32_bf16 v[172:175], a[8:11], a[192:195], v[172:175]
 s_waitcnt lgkmcnt(4)
 v_mfma_f32_16x16x32_bf16 v[64:67], a[16:19], a[168:171], v[64:67]
 s_waitcnt vmcnt(11)
 v_mfma_f32_16x16x32_bf16 v[64:67], a[20:23], a[172:175], v[64:67]
 s_barrier
 v_mfma_f32_16x16x32_bf16 v[68:71], a[76:79], a[172:175], v[68:71]
 global_load_lds_dwordx4 v252, s[72:73]
 v_mfma_f32_16x16x32_bf16 v[68:71], a[72:75], a[168:171], v[68:71]
 ds_read_b128 a[184:187], v6 offset:61440
 v_mfma_f32_16x16x32_bf16 v[72:75], a[128:131], a[168:171], v[72:75]
 s_waitcnt lgkmcnt(1)
 ds_read_b128 a[188:191], v7 offset:61440
 v_mfma_f32_16x16x32_bf16 v[72:75], a[132:135], a[172:175], v[72:75]
 global_load_dwordx2 v[54:55], v[52:53], off
 v_mfma_f32_16x16x32_bf16 v[84:87], a[132:135], a[180:183], v[84:87]
 s_add_u32 m0, s52, 32768
 ds_read_b128 a[196:199], v7 offset:63488
 v_mfma_f32_16x16x32_bf16 v[84:87], a[128:131], a[176:179], v[84:87]
 ds_read_b128 a[192:195], v6 offset:63488
 v_mfma_f32_16x16x32_bf16 v[80:83], a[72:75], a[176:179], v[80:83]
 global_load_lds_dwordx4 v243, s[10:11]
 v_mfma_f32_16x16x32_bf16 v[80:83], a[76:79], a[180:183], v[80:83]
 s_add_u32 m0, s52, 36864
 ds_read_b64_tr_b16 a[24:25], v11 offset:53248
 v_mfma_f32_16x16x32_bf16 v[76:79], a[20:23], a[180:183], v[76:79]
 ds_read_b64_tr_b16 a[26:27], v11 offset:53760
 v_mfma_f32_16x16x32_bf16 v[76:79], a[16:19], a[176:179], v[76:79]
 s_waitcnt lgkmcnt(3)
 ds_read_b64_tr_b16 a[28:29], v11 offset:57344
 v_mfma_f32_16x16x32_bf16 v[88:91], a[16:19], a[184:187], v[88:91]
 s_waitcnt vmcnt(12)
 ds_read_b64_tr_b16 a[30:31], v11 offset:57856
 v_mfma_f32_16x16x32_bf16 v[88:91], a[20:23], a[188:191], v[88:91]
 s_barrier
 v_mfma_f32_16x16x32_bf16 v[92:95], a[76:79], a[188:191], v[92:95]
 global_load_lds_dwordx4 v252, s[70:71]
 v_mfma_f32_16x16x32_bf16 v[92:95], a[72:75], a[184:187], v[92:95]
 s_add_u32 m0, s52, 40960
 ds_read_b128 a[168:171], v8 offset:4096
 v_mfma_f32_16x16x32_bf16 v[96:99], a[128:131], a[184:187], v[96:99]
 ds_read_b128 a[172:175], v9 offset:4096
 v_mfma_f32_16x16x32_bf16 v[96:99], a[132:135], a[188:191], v[96:99]
 s_waitcnt lgkmcnt(6)
 ds_read_b128 a[180:183], v9 offset:6144
 v_mfma_f32_16x16x32_bf16 v[108:111], a[132:135], a[196:199], v[108:111]
 global_load_lds_dwordx4 v243, s[12:13]
 v_mfma_f32_16x16x32_bf16 v[108:111], a[128:131], a[192:195], v[108:111]
 s_add_u32 m0, s52, 45056
 ds_read_b128 a[176:179], v8 offset:6144
 v_mfma_f32_16x16x32_bf16 v[104:107], a[72:75], a[192:195], v[104:107]
 ds_read_b64_tr_b16 a[84:85], v12 offset:0
 v_mfma_f32_16x16x32_bf16 v[104:107], a[76:79], a[196:199], v[104:107]
 ds_read_b64_tr_b16 a[86:87], v12 offset:512
 v_mfma_f32_16x16x32_bf16 v[100:103], a[20:23], a[196:199], v[100:103]
 v_mfma_f32_16x16x32_bf16 v[100:103], a[16:19], a[192:195], v[100:103]
 s_waitcnt lgkmcnt(3)
 v_mfma_f32_16x16x32_bf16 v[112:115], a[16:19], a[168:171], v[112:115]
 s_waitcnt vmcnt(12)
 v_mfma_f32_16x16x32_bf16 v[112:115], a[20:23], a[172:175], v[112:115]
 s_barrier
 v_mfma_f32_16x16x32_bf16 v[116:119], a[76:79], a[172:175], v[116:119]
 global_load_lds_dwordx4 v252, s[74:75]
 v_mfma_f32_16x16x32_bf16 v[116:119], a[72:75], a[168:171], v[116:119]
 s_add_u32 m0, s52, 49152
 ds_read_b128 a[184:187], v8 offset:12288
 v_mfma_f32_16x16x32_bf16 v[120:123], a[128:131], a[168:171], v[120:123]
 ds_read_b128 a[188:191], v9 offset:12288
 v_mfma_f32_16x16x32_bf16 v[120:123], a[132:135], a[172:175], v[120:123]
 s_waitcnt lgkmcnt(4)
 ds_read_b128 a[196:199], v9 offset:14336
 v_mfma_f32_16x16x32_bf16 v[132:135], a[132:135], a[180:183], v[132:135]
 global_load_lds_dwordx4 v243, s[14:15]
 v_mfma_f32_16x16x32_bf16 v[132:135], a[128:131], a[176:179], v[132:135]
 s_add_u32 m0, s52, 53248
 ds_read_b128 a[192:195], v8 offset:14336
 v_mfma_f32_16x16x32_bf16 v[128:131], a[72:75], a[176:179], v[128:131]
 ds_read_b64_tr_b16 a[80:81], v12 offset:8192
 v_mfma_f32_16x16x32_bf16 v[128:131], a[76:79], a[180:183], v[128:131]
 ds_read_b64_tr_b16 a[82:83], v12 offset:8704
 v_mfma_f32_16x16x32_bf16 v[124:127], a[20:23], a[180:183], v[124:127]
 v_mfma_f32_16x16x32_bf16 v[124:127], a[16:19], a[176:179], v[124:127]
 s_waitcnt lgkmcnt(3)
 v_mfma_f32_16x16x32_bf16 v[136:139], a[16:19], a[184:187], v[136:139]
 s_waitcnt vmcnt(12)
 v_mfma_f32_16x16x32_bf16 v[136:139], a[20:23], a[188:191], v[136:139]
 s_barrier
 v_mfma_f32_16x16x32_bf16 v[140:143], a[76:79], a[188:191], v[140:143]
 global_load_lds_dwordx4 v252, s[62:63]
 v_mfma_f32_16x16x32_bf16 v[140:143], a[72:75], a[184:187], v[140:143]
 s_add_u32 m0, s52, 57344
 ds_read_b128 a[168:171], v4 offset:4096
 v_mfma_f32_16x16x32_bf16 v[144:147], a[128:131], a[184:187], v[144:147]
 ds_read_b128 a[172:175], v5 offset:4096
 v_mfma_f32_16x16x32_bf16 v[144:147], a[132:135], a[188:191], v[144:147]
 s_waitcnt lgkmcnt(4)
 ds_read_b128 a[180:183], v5 offset:6144
 v_mfma_f32_16x16x32_bf16 v[156:159], a[132:135], a[196:199], v[156:159]
 global_load_lds_dwordx4 v244, s[20:21]
 v_mfma_f32_16x16x32_bf16 v[156:159], a[128:131], a[192:195], v[156:159]
 s_add_u32 m0, s52, 61440
 ds_read_b128 a[176:179], v4 offset:6144
 v_mfma_f32_16x16x32_bf16 v[152:155], a[72:75], a[192:195], v[152:155]
 ds_read_b64_tr_b16 a[136:137], v10 offset:0
 v_mfma_f32_16x16x32_bf16 v[152:155], a[76:79], a[196:199], v[152:155]
 ds_read_b64_tr_b16 a[138:139], v10 offset:512
 v_mfma_f32_16x16x32_bf16 v[148:151], a[20:23], a[196:199], v[148:151]
 v_mfma_f32_16x16x32_bf16 v[148:151], a[16:19], a[192:195], v[148:151]
 s_waitcnt lgkmcnt(3)
 v_mfma_f32_16x16x32_bf16 v[160:163], a[16:19], a[168:171], v[160:163]
 s_waitcnt vmcnt(12)
 v_mfma_f32_16x16x32_bf16 v[160:163], a[20:23], a[172:175], v[160:163]
 s_barrier
 v_mfma_f32_16x16x32_bf16 v[164:167], a[76:79], a[172:175], v[164:167]
 global_load_lds_dwordx4 v253, s[24:25]
 v_mfma_f32_16x16x32_bf16 v[164:167], a[72:75], a[168:171], v[164:167]
 s_add_u32 m0, s52, 65536
 ds_read_b128 a[184:187], v4 offset:12288
 v_mfma_f32_16x16x32_bf16 v[168:171], a[128:131], a[168:171], v[168:171]
 ds_read_b128 a[188:191], v5 offset:12288
 v_mfma_f32_16x16x32_bf16 v[168:171], a[132:135], a[172:175], v[168:171]
 s_waitcnt lgkmcnt(4)
 ds_read_b64_tr_b16 a[140:141], v10 offset:8192
 v_mfma_f32_16x16x32_bf16 v[180:183], a[132:135], a[180:183], v[180:183]
 global_load_lds_dwordx4 v253, s[16:17]
 v_mfma_f32_16x16x32_bf16 v[180:183], a[128:131], a[176:179], v[180:183]
 s_add_u32 m0, s52, 69632
 ds_read_b64_tr_b16 a[142:143], v10 offset:8704
 v_mfma_f32_16x16x32_bf16 v[176:179], a[72:75], a[176:179], v[176:179]
 ds_read_b128 a[196:199], v5 offset:14336
 v_mfma_f32_16x16x32_bf16 v[176:179], a[76:79], a[180:183], v[176:179]
 ds_read_b128 a[192:195], v4 offset:14336
 v_mfma_f32_16x16x32_bf16 v[172:175], a[20:23], a[180:183], v[172:175]
 v_mfma_f32_16x16x32_bf16 v[172:175], a[16:19], a[176:179], v[172:175]
 s_waitcnt lgkmcnt(4)
 v_mfma_f32_16x16x32_bf16 v[64:67], a[24:27], a[184:187], v[64:67]
 s_waitcnt vmcnt(11)
 v_mfma_f32_16x16x32_bf16 v[64:67], a[28:31], a[188:191], v[64:67]
 s_barrier
 v_mfma_f32_16x16x32_bf16 v[68:71], a[84:87], a[188:191], v[68:71]
 global_load_lds_dwordx4 v244, s[8:9]
 v_mfma_f32_16x16x32_bf16 v[68:71], a[80:83], a[184:187], v[68:71]
 s_add_u32 m0, s52, 73728
 ds_read_b128 a[168:171], v4 offset:24576
 v_mfma_f32_16x16x32_bf16 v[72:75], a[136:139], a[184:187], v[72:75]
 s_waitcnt lgkmcnt(1)
 ds_read_b128 a[172:175], v5 offset:24576
 v_mfma_f32_16x16x32_bf16 v[72:75], a[140:143], a[188:191], v[72:75]
 global_load_lds_dwordx4 v253, s[72:73]
 v_mfma_f32_16x16x32_bf16 v[84:87], a[140:143], a[196:199], v[84:87]
 s_add_u32 m0, s52, 77824
 ds_read_b128 a[180:183], v5 offset:26624
 v_mfma_f32_16x16x32_bf16 v[84:87], a[136:139], a[192:195], v[84:87]
 ds_read_b128 a[176:179], v4 offset:26624
 v_mfma_f32_16x16x32_bf16 v[80:83], a[80:83], a[192:195], v[80:83]
 global_load_lds_dwordx4 v244, s[10:11]
 v_mfma_f32_16x16x32_bf16 v[80:83], a[84:87], a[196:199], v[80:83]
 s_add_u32 m0, s52, 81920
 ds_read_b64_tr_b16 a[32:33], v10 offset:16384
 v_mfma_f32_16x16x32_bf16 v[76:79], a[28:31], a[196:199], v[76:79]
 ds_read_b64_tr_b16 a[34:35], v10 offset:16896
 v_mfma_f32_16x16x32_bf16 v[76:79], a[24:27], a[192:195], v[76:79]
 s_waitcnt lgkmcnt(3)
 ds_read_b64_tr_b16 a[36:37], v10 offset:20480
 v_mfma_f32_16x16x32_bf16 v[88:91], a[24:27], a[168:171], v[88:91]
 s_waitcnt vmcnt(11)
 ds_read_b64_tr_b16 a[38:39], v10 offset:20992
 v_mov_b32_dpp v56, v54 quad_perm:[0,0,0,0] row_mask:0xf bank_mask:0xf
 v_mfma_f32_16x16x32_bf16 v[88:91], a[28:31], a[172:175], v[88:91]
 s_barrier
 v_mfma_f32_16x16x32_bf16 v[92:95], a[84:87], a[172:175], v[92:95]
 global_load_lds_dwordx4 v253, s[70:71]
 v_mfma_f32_16x16x32_bf16 v[92:95], a[80:83], a[168:171], v[92:95]
 s_add_u32 m0, s52, 86016
 ds_read_b128 a[184:187], v4 offset:32768
 v_mov_b32_dpp v57, v55 quad_perm:[0,0,0,0] row_mask:0xf bank_mask:0xf
 v_mfma_f32_16x16x32_bf16 v[96:99], a[136:139], a[168:171], v[96:99]
 ds_read_b128 a[188:191], v5 offset:32768
 v_mov_b32_dpp v58, v54 quad_perm:[1,1,1,1] row_mask:0xf bank_mask:0xf
 v_mfma_f32_16x16x32_bf16 v[96:99], a[140:143], a[172:175], v[96:99]
 s_waitcnt lgkmcnt(6)
 ds_read_b128 a[196:199], v5 offset:34816
 v_mov_b32_dpp v59, v55 quad_perm:[1,1,1,1] row_mask:0xf bank_mask:0xf
 v_mfma_f32_16x16x32_bf16 v[108:111], a[140:143], a[180:183], v[108:111]
 global_load_lds_dwordx4 v244, s[12:13]
 v_mfma_f32_16x16x32_bf16 v[108:111], a[136:139], a[176:179], v[108:111]
 s_add_u32 m0, s52, 90112
 ds_read_b128 a[192:195], v4 offset:34816
 v_mov_b32_dpp v60, v54 quad_perm:[2,2,2,2] row_mask:0xf bank_mask:0xf
 v_mfma_f32_16x16x32_bf16 v[104:107], a[80:83], a[176:179], v[104:107]
 ds_read_b64_tr_b16 a[92:93], v10 offset:28672
 v_mov_b32_dpp v61, v55 quad_perm:[2,2,2,2] row_mask:0xf bank_mask:0xf
 v_mfma_f32_16x16x32_bf16 v[104:107], a[84:87], a[180:183], v[104:107]
 global_load_lds_dwordx4 v253, s[74:75]
 v_mfma_f32_16x16x32_bf16 v[100:103], a[28:31], a[180:183], v[100:103]
 s_add_u32 m0, s52, 94208
 ds_read_b64_tr_b16 a[94:95], v10 offset:29184
 v_mov_b32_dpp v62, v54 quad_perm:[3,3,3,3] row_mask:0xf bank_mask:0xf
 v_mfma_f32_16x16x32_bf16 v[100:103], a[24:27], a[176:179], v[100:103]
 s_waitcnt lgkmcnt(3)
 v_mov_b32_dpp v63, v55 quad_perm:[3,3,3,3] row_mask:0xf bank_mask:0xf
 v_lshlrev_b32 v28, 16, v56
 v_mfma_f32_16x16x32_bf16 v[112:115], a[24:27], a[184:187], v[112:115]
 s_waitcnt vmcnt(12)
 v_and_b32 v29, 0xffff0000, v56
 v_lshlrev_b32 v30, 16, v57
 v_mfma_f32_16x16x32_bf16 v[112:115], a[28:31], a[188:191], v[112:115]
 s_barrier
 v_mfma_f32_16x16x32_bf16 v[116:119], a[84:87], a[188:191], v[116:119]
 global_load_lds_dwordx4 v244, s[14:15]
 v_mfma_f32_16x16x32_bf16 v[116:119], a[80:83], a[184:187], v[116:119]
 s_add_u32 m0, s52, 98304
 ds_read_b128 a[168:171], v4 offset:40960
 v_and_b32 v31, 0xffff0000, v57
 v_mfma_f32_16x16x32_bf16 v[120:123], a[136:139], a[184:187], v[120:123]
 ds_read_b128 a[172:175], v5 offset:40960
 v_lshlrev_b32 v32, 16, v58
 v_mfma_f32_16x16x32_bf16 v[120:123], a[140:143], a[188:191], v[120:123]
 s_waitcnt lgkmcnt(4)
 ds_read_b128 a[180:183], v5 offset:43008
 v_and_b32 v33, 0xffff0000, v58
 v_mfma_f32_16x16x32_bf16 v[132:135], a[140:143], a[196:199], v[132:135]
 global_load_lds_dwordx4 v253, s[62:63]
 v_mfma_f32_16x16x32_bf16 v[132:135], a[136:139], a[192:195], v[132:135]
 s_add_u32 m0, s52, 102400
 ds_read_b128 a[176:179], v4 offset:43008
 v_lshlrev_b32 v34, 16, v59
 v_mfma_f32_16x16x32_bf16 v[128:131], a[80:83], a[192:195], v[128:131]
 ds_read_b64_tr_b16 a[88:89], v10 offset:36864
 v_and_b32 v35, 0xffff0000, v59
 v_mfma_f32_16x16x32_bf16 v[128:131], a[84:87], a[196:199], v[128:131]
 ds_read_b64_tr_b16 a[90:91], v10 offset:37376
 v_lshlrev_b32 v36, 16, v60
 v_mfma_f32_16x16x32_bf16 v[124:127], a[28:31], a[196:199], v[124:127]
 v_and_b32 v37, 0xffff0000, v60
 v_lshlrev_b32 v38, 16, v61
 v_mfma_f32_16x16x32_bf16 v[124:127], a[24:27], a[192:195], v[124:127]
 s_waitcnt lgkmcnt(3)
 v_and_b32 v39, 0xffff0000, v61
 v_lshlrev_b32 v40, 16, v62
 v_mfma_f32_16x16x32_bf16 v[136:139], a[24:27], a[168:171], v[136:139]
 s_waitcnt vmcnt(12)
 v_and_b32 v41, 0xffff0000, v62
 v_lshlrev_b32 v42, 16, v63
 v_mfma_f32_16x16x32_bf16 v[136:139], a[28:31], a[172:175], v[136:139]
 s_barrier
 v_mfma_f32_16x16x32_bf16 v[140:143], a[84:87], a[172:175], v[140:143]
 global_load_lds_dwordx4 v245, s[20:21]
 v_mfma_f32_16x16x32_bf16 v[140:143], a[80:83], a[168:171], v[140:143]
 s_add_u32 m0, s52, 106496
 ds_read_b128 a[184:187], v4 offset:49152
 v_and_b32 v43, 0xffff0000, v63
 v_mfma_f32_16x16x32_bf16 v[144:147], a[136:139], a[168:171], v[144:147]
 ds_read_b128 a[188:191], v5 offset:49152
 v_add_f32 v32, 0x3727c5ac, v32
 v_mfma_f32_16x16x32_bf16 v[144:147], a[140:143], a[172:175], v[144:147]
 s_waitcnt lgkmcnt(4)
 ds_read_b128 a[196:199], v5 offset:51200
 v_add_f32 v33, 0x3727c5ac, v33
 v_mfma_f32_16x16x32_bf16 v[156:159], a[140:143], a[180:183], v[156:159]
 global_load_lds_dwordx4 v254, s[24:25]
 v_mfma_f32_16x16x32_bf16 v[156:159], a[136:139], a[176:179], v[156:159]
 s_add_u32 m0, s52, 110592
 ds_read_b128 a[192:195], v4 offset:51200
 v_add_f32 v34, 0x3727c5ac, v34
 v_mfma_f32_16x16x32_bf16 v[152:155], a[80:83], a[176:179], v[152:155]
 ds_read_b64_tr_b16 a[144:145], v10 offset:45056
 v_add_f32 v35, 0x3727c5ac, v35
 v_mfma_f32_16x16x32_bf16 v[152:155], a[84:87], a[180:183], v[152:155]
 ds_read_b64_tr_b16 a[146:147], v10 offset:45568
 v_cvt_pk_bf16_f32 v32, v32, v32
 v_mfma_f32_16x16x32_bf16 v[148:151], a[28:31], a[180:183], v[148:151]
 v_cvt_pk_bf16_f32 v33, v33, v33
 v_cvt_pk_bf16_f32 v34, v34, v34
 v_mfma_f32_16x16x32_bf16 v[148:151], a[24:27], a[176:179], v[148:151]
 s_waitcnt lgkmcnt(3)
 v_cvt_pk_bf16_f32 v35, v35, v35
 v_and_b32 v32, 0xffff0000, v32
 v_mfma_f32_16x16x32_bf16 v[160:163], a[24:27], a[184:187], v[160:163]
 s_waitcnt vmcnt(12)
 v_and_b32 v33, 0xffff0000, v33
 v_and_b32 v34, 0xffff0000, v34
 v_mfma_f32_16x16x32_bf16 v[160:163], a[28:31], a[188:191], v[160:163]
 s_barrier
 v_mfma_f32_16x16x32_bf16 v[164:167], a[84:87], a[188:191], v[164:167]
 global_load_lds_dwordx4 v254, s[16:17]
 v_mfma_f32_16x16x32_bf16 v[164:167], a[80:83], a[184:187], v[164:167]
 s_add_u32 m0, s52, 114688
 ds_read_b128 a[168:171], v4 offset:57344
 v_and_b32 v35, 0xffff0000, v35
 v_mfma_f32_16x16x32_bf16 v[168:171], a[136:139], a[184:187], v[168:171]
 v_sqrt_f32 v32, v32
 v_mfma_f32_16x16x32_bf16 v[168:171], a[140:143], a[188:191], v[168:171]
 s_waitcnt lgkmcnt(3)
 ds_read_b128 a[172:175], v5 offset:57344
 v_mfma_f32_16x16x32_bf16 v[180:183], a[140:143], a[196:199], v[180:183]
 global_load_lds_dwordx4 v245, s[8:9]
 v_mfma_f32_16x16x32_bf16 v[180:183], a[136:139], a[192:195], v[180:183]
 s_add_u32 m0, s52, 118784
 ds_read_b64_tr_b16 a[148:149], v10 offset:53248
 ds_read_b64_tr_b16 a[150:151], v10 offset:53760
 v_mfma_f32_16x16x32_bf16 v[176:179], a[80:83], a[192:195], v[176:179]
 v_sqrt_f32 v33, v33
 v_mfma_f32_16x16x32_bf16 v[176:179], a[84:87], a[196:199], v[176:179]
 v_sqrt_f32 v34, v34
 v_mfma_f32_16x16x32_bf16 v[172:175], a[28:31], a[196:199], v[172:175]
 ds_read_b128 a[180:183], v5 offset:59392
 v_mfma_f32_16x16x32_bf16 v[172:175], a[24:27], a[192:195], v[172:175]
 s_waitcnt lgkmcnt(3)
 ds_read_b128 a[176:179], v4 offset:59392
 v_mfma_f32_16x16x32_bf16 v[64:67], a[32:35], a[168:171], v[64:67]
 s_waitcnt vmcnt(11)
 v_sqrt_f32 v35, v35
 v_mfma_f32_16x16x32_bf16 v[64:67], a[36:39], a[172:175], v[64:67]
 s_barrier
 v_mfma_f32_16x16x32_bf16 v[68:71], a[92:95], a[172:175], v[68:71]
 global_load_lds_dwordx4 v254, s[72:73]
 v_mfma_f32_16x16x32_bf16 v[68:71], a[88:91], a[168:171], v[68:71]
 s_add_u32 m0, s52, 122880
 ds_read_b128 a[184:187], v6 offset:4096
 v_cvt_pk_bf16_f32 v32, v32, v32
 v_mfma_f32_16x16x32_bf16 v[72:75], a[144:147], a[168:171], v[72:75]
 s_waitcnt lgkmcnt(1)
 ds_read_b128 a[188:191], v7 offset:4096
 v_cvt_pk_bf16_f32 v33, v33, v33
 v_mfma_f32_16x16x32_bf16 v[72:75], a[148:151], a[172:175], v[72:75]
 global_load_lds_dwordx4 v245, s[10:11]
 v_mfma_f32_16x16x32_bf16 v[84:87], a[148:151], a[180:183], v[84:87]
 s_add_u32 m0, s52, 126976
 ds_read_b128 a[196:199], v7 offset:6144
 v_cvt_pk_bf16_f32 v34, v34, v34
 v_mfma_f32_16x16x32_bf16 v[84:87], a[144:147], a[176:179], v[84:87]
 ds_read_b128 a[192:195], v6 offset:6144
 v_cvt_pk_bf16_f32 v35, v35, v35
 v_mfma_f32_16x16x32_bf16 v[80:83], a[88:91], a[176:179], v[80:83]
 global_load_lds_dwordx4 v254, s[70:71]
 v_mfma_f32_16x16x32_bf16 v[80:83], a[92:95], a[180:183], v[80:83]
 s_add_u32 m0, s52, 131072
 ds_read_b64_tr_b16 a[40:41], v10 offset:61440
 v_and_b32 v32, 0xffff0000, v32
 v_mfma_f32_16x16x32_bf16 v[76:79], a[36:39], a[180:183], v[76:79]
 ds_read_b64_tr_b16 a[42:43], v10 offset:61952
 v_and_b32 v33, 0xffff0000, v33
 v_mfma_f32_16x16x32_bf16 v[76:79], a[32:35], a[176:179], v[76:79]
 s_waitcnt lgkmcnt(3)
 ds_read_b64_tr_b16 a[44:45], v11 offset:0
 v_and_b32 v34, 0xffff0000, v34
 v_mfma_f32_16x16x32_bf16 v[88:91], a[32:35], a[184:187], v[88:91]
 s_waitcnt vmcnt(12)
 ds_read_b64_tr_b16 a[46:47], v11 offset:512
 v_and_b32 v35, 0xffff0000, v35
 v_mfma_f32_16x16x32_bf16 v[88:91], a[36:39], a[188:191], v[88:91]
 s_barrier
 v_mfma_f32_16x16x32_bf16 v[92:95], a[92:95], a[188:191], v[92:95]
 global_load_lds_dwordx4 v245, s[12:13]
 v_mfma_f32_16x16x32_bf16 v[92:95], a[88:91], a[184:187], v[92:95]
 s_add_u32 m0, s52, 135168
 v_rcp_f32 v32, v32
 v_mfma_f32_16x16x32_bf16 v[96:99], a[144:147], a[184:187], v[96:99]
 ds_read_b128 a[168:171], v6 offset:12288
 v_mfma_f32_16x16x32_bf16 v[96:99], a[148:151], a[188:191], v[96:99]
 s_waitcnt lgkmcnt(5)
 ds_read_b128 a[172:175], v7 offset:12288
 v_mfma_f32_16x16x32_bf16 v[108:111], a[148:151], a[196:199], v[108:111]
 global_load_lds_dwordx4 v254, s[74:75]
 v_mfma_f32_16x16x32_bf16 v[108:111], a[144:147], a[192:195], v[108:111]
 s_add_u32 m0, s52, 139264
 v_rcp_f32 v33, v33
 v_mfma_f32_16x16x32_bf16 v[104:107], a[88:91], a[192:195], v[104:107]
 v_rcp_f32 v34, v34
 v_mfma_f32_16x16x32_bf16 v[104:107], a[92:95], a[196:199], v[104:107]
 v_rcp_f32 v35, v35
 v_mfma_f32_16x16x32_bf16 v[100:103], a[36:39], a[196:199], v[100:103]
 ds_read_b128 a[180:183], v7 offset:14336
 v_cvt_pk_bf16_f32 v32, v32, v32
 v_mfma_f32_16x16x32_bf16 v[100:103], a[32:35], a[192:195], v[100:103]
 s_waitcnt lgkmcnt(1)
 ds_read_b128 a[176:179], v6 offset:14336
 v_cvt_pk_bf16_f32 v33, v33, v33
 v_mfma_f32_16x16x32_bf16 v[112:115], a[32:35], a[168:171], v[112:115]
 s_waitcnt vmcnt(12)
 ds_read_b64_tr_b16 a[100:101], v11 offset:8192
 v_cvt_pk_bf16_f32 v34, v34, v34
 v_mfma_f32_16x16x32_bf16 v[112:115], a[36:39], a[172:175], v[112:115]
 s_barrier
 v_mfma_f32_16x16x32_bf16 v[116:119], a[92:95], a[172:175], v[116:119]
 global_load_lds_dwordx4 v245, s[14:15]
 v_mfma_f32_16x16x32_bf16 v[116:119], a[88:91], a[168:171], v[116:119]
 s_add_u32 m0, s52, 143360
 ds_read_b128 a[184:187], v6 offset:20480
 v_cvt_pk_bf16_f32 v35, v35, v35
 v_mfma_f32_16x16x32_bf16 v[120:123], a[144:147], a[168:171], v[120:123]
 ds_read_b128 a[188:191], v7 offset:20480
 v_and_b32 v32, 0xffff0000, v32
 v_mfma_f32_16x16x32_bf16 v[120:123], a[148:151], a[172:175], v[120:123]
 s_waitcnt lgkmcnt(3)
 ds_read_b128 a[196:199], v7 offset:22528
 v_and_b32 v33, 0xffff0000, v33
 v_mfma_f32_16x16x32_bf16 v[132:135], a[148:151], a[180:183], v[132:135]
 global_load_lds_dwordx4 v254, s[62:63]
 v_mfma_f32_16x16x32_bf16 v[132:135], a[144:147], a[176:179], v[132:135]
 s_add_u32 m0, s52, 0
 ds_read_b128 a[192:195], v6 offset:22528
 v_and_b32 v34, 0xffff0000, v34
 v_mfma_f32_16x16x32_bf16 v[128:131], a[88:91], a[176:179], v[128:131]
 ds_read_b64_tr_b16 a[102:103], v11 offset:8704
 v_and_b32 v35, 0xffff0000, v35
 v_mfma_f32_16x16x32_bf16 v[128:131], a[92:95], a[180:183], v[128:131]
 ds_read_b64_tr_b16 a[96:97], v11 offset:16384
 v_mul_f32 v32, v36, v32
 v_mfma_f32_16x16x32_bf16 v[124:127], a[36:39], a[180:183], v[124:127]
 ds_read_b64_tr_b16 a[98:99], v11 offset:16896
 v_mul_f32 v33, v37, v33
 v_mfma_f32_16x16x32_bf16 v[124:127], a[32:35], a[176:179], v[124:127]
 s_waitcnt lgkmcnt(4)
 v_mul_f32 v34, v38, v34
 v_mul_f32 v35, v39, v35
 v_mfma_f32_16x16x32_bf16 v[136:139], a[32:35], a[184:187], v[136:139]
 s_waitcnt vmcnt(12)
 v_cvt_pk_bf16_f32 v32, v32, v32
 v_cvt_pk_bf16_f32 v33, v33, v33
 v_mfma_f32_16x16x32_bf16 v[136:139], a[36:39], a[188:191], v[136:139]
 s_barrier
 v_mfma_f32_16x16x32_bf16 v[140:143], a[92:95], a[188:191], v[140:143]
 global_load_lds_dwordx4 v246, s[20:21]
 v_mfma_f32_16x16x32_bf16 v[140:143], a[88:91], a[184:187], v[140:143]
 s_add_u32 m0, s52, 4096
 ds_read_b128 a[168:171], v6 offset:28672
 v_cvt_pk_bf16_f32 v34, v34, v34
 v_mfma_f32_16x16x32_bf16 v[144:147], a[144:147], a[184:187], v[144:147]
 ds_read_b128 a[172:175], v7 offset:28672
 v_cvt_pk_bf16_f32 v35, v35, v35
 v_mfma_f32_16x16x32_bf16 v[144:147], a[148:151], a[188:191], v[144:147]
 s_waitcnt lgkmcnt(5)
 ds_read_b128 a[180:183], v7 offset:30720
 v_and_b32 v32, 0xffff0000, v32
 v_mfma_f32_16x16x32_bf16 v[156:159], a[148:151], a[196:199], v[156:159]
 global_load_lds_dwordx4 v246, s[8:9]
 v_mfma_f32_16x16x32_bf16 v[156:159], a[144:147], a[192:195], v[156:159]
 s_add_u32 m0, s52, 8192
 ds_read_b128 a[176:179], v6 offset:30720
 v_and_b32 v33, 0xffff0000, v33
 v_mfma_f32_16x16x32_bf16 v[152:155], a[88:91], a[192:195], v[152:155]
 ds_read_b64_tr_b16 a[152:153], v11 offset:24576
 v_and_b32 v34, 0xffff0000, v34
 v_mfma_f32_16x16x32_bf16 v[152:155], a[92:95], a[196:199], v[152:155]
 ds_read_b64_tr_b16 a[154:155], v11 offset:25088
 v_and_b32 v35, 0xffff0000, v35
 v_mfma_f32_16x16x32_bf16 v[148:151], a[36:39], a[196:199], v[148:151]
 v_mov_b32 v24, 0xbfb8aa3b
 v_fma_f32 v40, -v28, v32, v40
 v_mfma_f32_16x16x32_bf16 v[148:151], a[32:35], a[192:195], v[148:151]
 s_waitcnt lgkmcnt(3)
 v_fma_f32 v41, -v29, v33, v41
 v_fma_f32 v42, -v30, v34, v42
 v_mfma_f32_16x16x32_bf16 v[160:163], a[32:35], a[168:171], v[160:163]
 s_waitcnt vmcnt(12)
 v_fma_f32 v43, -v31, v35, v43
 v_mul_f32 v16, v24, v32
 v_mfma_f32_16x16x32_bf16 v[160:163], a[36:39], a[172:175], v[160:163]
 s_barrier
 v_mfma_f32_16x16x32_bf16 v[164:167], a[92:95], a[172:175], v[164:167]
 global_load_lds_dwordx4 v246, s[10:11]
 v_mfma_f32_16x16x32_bf16 v[164:167], a[88:91], a[168:171], v[164:167]
 s_add_u32 m0, s52, 12288
 ds_read_b128 a[184:187], v6 offset:36864
 v_mul_f32 v17, v24, v33
 v_mfma_f32_16x16x32_bf16 v[168:171], a[144:147], a[168:171], v[168:171]
 ds_read_b128 a[188:191], v7 offset:36864
 v_mul_f32 v18, v24, v34
 v_mfma_f32_16x16x32_bf16 v[168:171], a[148:151], a[172:175], v[168:171]
 s_waitcnt lgkmcnt(4)
 ds_read_b64_tr_b16 a[156:157], v11 offset:32768
 v_mul_f32 v19, v24, v35
 v_mfma_f32_16x16x32_bf16 v[180:183], a[148:151], a[180:183], v[180:183]
 global_load_lds_dwordx4 v246, s[12:13]
 v_mfma_f32_16x16x32_bf16 v[180:183], a[144:147], a[176:179], v[180:183]
 s_add_u32 m0, s52, 16384
 ds_read_b64_tr_b16 a[158:159], v11 offset:33280
 v_mul_f32 v20, v24, v40
 v_mfma_f32_16x16x32_bf16 v[176:179], a[88:91], a[176:179], v[176:179]
 ds_read_b128 a[196:199], v7 offset:38912
 v_mul_f32 v21, v24, v41
 v_mfma_f32_16x16x32_bf16 v[176:179], a[92:95], a[180:183], v[176:179]
 ds_read_b128 a[192:195], v6 offset:38912
 v_mul_f32 v22, v24, v42
 v_mfma_f32_16x16x32_bf16 v[172:175], a[36:39], a[180:183], v[172:175]
L_pad2:
 s_cbranch_execz L_pad6
 v_mul_f32 v23, v24, v43
 v_mfma_f32_16x16x32_bf16 v[172:175], a[32:35], a[176:179], v[172:175]
 s_waitcnt lgkmcnt(4)
 v_mfma_f32_16x16x32_bf16 v[64:67], a[40:43], a[184:187], v[64:67]
 s_waitcnt vmcnt(11)
 v_mfma_f32_16x16x32_bf16 v[64:67], a[44:47], a[188:191], v[64:67]
 s_barrier
 v_mfma_f32_16x16x32_bf16 v[68:71], a[100:103], a[188:191], v[68:71]
 global_load_lds_dwordx4 v246, s[14:15]
 v_mfma_f32_16x16x32_bf16 v[68:71], a[96:99], a[184:187], v[68:71]
 s_add_u32 m0, s52, 20480
 s_add_u32 s32, s20, 143360
 ds_read_b128 a[168:171], v6 offset:49152
 v_mfma_f32_16x16x32_bf16 v[72:75], a[152:155], a[184:187], v[72:75]
 s_waitcnt lgkmcnt(1)
 ds_read_b128 a[172:175], v7 offset:49152
 v_mfma_f32_16x16x32_bf16 v[72:75], a[156:159], a[188:191], v[72:75]
 s_addc_u32 s33, s21, 0
 ds_read_b128 a[180:183], v7 offset:51200
 v_mfma_f32_16x16x32_bf16 v[84:87], a[156:159], a[196:199], v[84:87]
 global_load_lds_dwordx4 v240, s[32:33]
 v_mfma_f32_16x16x32_bf16 v[84:87], a[152:155], a[192:195], v[84:87]
 s_add_u32 m0, s52, 24576
 s_add_u32 s58, s20, 143360
 ds_read_b128 a[176:179], v6 offset:51200
 v_mfma_f32_16x16x32_bf16 v[80:83], a[96:99], a[192:195], v[80:83]
 s_addc_u32 s59, s21, 0
 ds_read_b64_tr_b16 a[48:49], v11 offset:40960
 v_mfma_f32_16x16x32_bf16 v[80:83], a[100:103], a[196:199], v[80:83]
 global_load_lds_dwordx4 v241, s[58:59]
 v_mfma_f32_16x16x32_bf16 v[76:79], a[44:47], a[196:199], v[76:79]
 s_add_u32 m0, s52, 28672
 ds_read_b64_tr_b16 a[50:51], v11 offset:41472
 v_mfma_f32_16x16x32_bf16 v[76:79], a[40:43], a[192:195], v[76:79]
 s_waitcnt lgkmcnt(3)
 ds_read_b64_tr_b16 a[52:53], v11 offset:45056
 v_mfma_f32_16x16x32_bf16 v[88:91], a[40:43], a[168:171], v[88:91]
 s_waitcnt vmcnt(12)
 ds_read_b64_tr_b16 a[54:55], v11 offset:45568
 v_mfma_f32_16x16x32_bf16 v[88:91], a[44:47], a[172:175], v[88:91]
 s_barrier
 v_mfma_f32_16x16x32_bf16 v[92:95], a[100:103], a[172:175], v[92:95]
 global_load_lds_dwordx4 v242, s[58:59]
 v_mfma_f32_16x16x32_bf16 v[92:95], a[96:99], a[168:171], v[92:95]
 s_add_u32 m0, s52, 32768
 ds_read_b128 a[184:187], v6 offset:57344
 v_mfma_f32_16x16x32_bf16 v[96:99], a[152:155], a[168:171], v[96:99]
 ds_read_b128 a[188:191], v7 offset:57344
 v_mfma_f32_16x16x32_bf16 v[96:99], a[156:159], a[172:175], v[96:99]
 s_waitcnt lgkmcnt(6)
 ds_read_b128 a[196:199], v7 offset:59392
 v_mfma_f32_16x16x32_bf16 v[108:111], a[156:159], a[180:183], v[108:111]
 global_load_lds_dwordx4 v243, s[58:59]
 v_mfma_f32_16x16x32_bf16 v[108:111], a[152:155], a[176:179], v[108:111]
 s_add_u32 m0, s52, 36864
 ds_read_b128 a[192:195], v6 offset:59392
 v_mfma_f32_16x16x32_bf16 v[104:107], a[96:99], a[176:179], v[104:107]
 ds_read_b64_tr_b16 a[108:109], v11 offset:53248
 v_mfma_f32_16x16x32_bf16 v[104:107], a[100:103], a[180:183], v[104:107]
 ds_read_b64_tr_b16 a[110:111], v11 offset:53760
 v_mfma_f32_16x16x32_bf16 v[100:103], a[44:47], a[180:183], v[100:103]
 v_mfma_f32_16x16x32_bf16 v[100:103], a[40:43], a[176:179], v[100:103]
 s_waitcnt lgkmcnt(3)
 v_mfma_f32_16x16x32_bf16 v[112:115], a[40:43], a[184:187], v[112:115]
 s_waitcnt vmcnt(12)
 v_mfma_f32_16x16x32_bf16 v[112:115], a[44:47], a[188:191], v[112:115]
 s_barrier
 v_mfma_f32_16x16x32_bf16 v[116:119], a[100:103], a[188:191], v[116:119]
 global_load_lds_dwordx4 v244, s[58:59]
 v_mfma_f32_16x16x32_bf16 v[116:119], a[96:99], a[184:187], v[116:119]
 s_add_u32 m0, s52, 40960
 ds_read_b128 a[168:171], v8 offset:0
 v_mfma_f32_16x16x32_bf16 v[120:123], a[152:155], a[184:187], v[120:123]
 ds_read_b128 a[172:175], v9 offset:0
 v_mfma_f32_16x16x32_bf16 v[120:123], a[156:159], a[188:191], v[120:123]
 s_waitcnt lgkmcnt(4)
 ds_read_b128 a[180:183], v9 offset:2048
 v_mfma_f32_16x16x32_bf16 v[132:135], a[156:159], a[196:199], v[132:135]
 global_load_lds_dwordx4 v245, s[58:59]
 v_mfma_f32_16x16x32_bf16 v[132:135], a[152:155], a[192:195], v[132:135]
 s_add_u32 m0, s52, 45056
 ds_read_b128 a[176:179], v8 offset:2048
 v_mfma_f32_16x16x32_bf16 v[128:131], a[96:99], a[192:195], v[128:131]
 ds_read_b64_tr_b16 a[104:105], v11 offset:61440
 v_mfma_f32_16x16x32_bf16 v[128:131], a[100:103], a[196:199], v[128:131]
 ds_read_b64_tr_b16 a[106:107], v11 offset:61952
 v_mfma_f32_16x16x32_bf16 v[124:127], a[44:47], a[196:199], v[124:127]
 v_mfma_f32_16x16x32_bf16 v[124:127], a[40:43], a[192:195], v[124:127]
 s_waitcnt lgkmcnt(3)
 v_mfma_f32_16x16x32_bf16 v[136:139], a[40:43], a[168:171], v[136:139]
 s_waitcnt vmcnt(12)
 v_mfma_f32_16x16x32_bf16 v[136:139], a[44:47], a[172:175], v[136:139]
 s_barrier
 v_mfma_f32_16x16x32_bf16 v[140:143], a[100:103], a[172:175], v[140:143]
 global_load_lds_dwordx4 v246, s[58:59]
 v_mfma_f32_16x16x32_bf16 v[140:143], a[96:99], a[168:171], v[140:143]
 s_add_u32 m0, s52, 49152
 s_add_u32 s32, s20, 172032
 ds_read_b128 a[184:187], v8 offset:8192
 v_mfma_f32_16x16x32_bf16 v[144:147], a[152:155], a[168:171], v[144:147]
 s_addc_u32 s33, s21, 0
 ds_read_b128 a[188:191], v9 offset:8192
 v_mfma_f32_16x16x32_bf16 v[144:147], a[156:159], a[172:175], v[144:147]
 s_waitcnt lgkmcnt(4)
 ds_read_b128 a[196:199], v9 offset:10240
 v_mfma_f32_16x16x32_bf16 v[156:159], a[156:159], a[180:183], v[156:159]
 global_load_lds_dwordx4 v240, s[32:33]
 v_mfma_f32_16x16x32_bf16 v[156:159], a[152:155], a[176:179], v[156:159]
 s_add_u32 m0, s52, 53248
 s_add_u32 s32, s20, 200704
 ds_read_b128 a[192:195], v8 offset:10240
 v_mfma_f32_16x16x32_bf16 v[152:155], a[96:99], a[176:179], v[152:155]
 s_addc_u32 s33, s21, 0
 ds_read_b64_tr_b16 a[160:161], v12 offset:4096
 v_mfma_f32_16x16x32_bf16 v[152:155], a[100:103], a[180:183], v[152:155]
 ds_read_b64_tr_b16 a[162:163], v12 offset:4608
 v_mfma_f32_16x16x32_bf16 v[148:151], a[44:47], a[180:183], v[148:151]
 v_mfma_f32_16x16x32_bf16 v[148:151], a[40:43], a[176:179], v[148:151]
 s_waitcnt lgkmcnt(3)
 v_mfma_f32_16x16x32_bf16 v[160:163], a[40:43], a[184:187], v[160:163]
 s_waitcnt vmcnt(12)
 v_mfma_f32_16x16x32_bf16 v[160:163], a[44:47], a[188:191], v[160:163]
 s_barrier
 v_mfma_f32_16x16x32_bf16 v[164:167], a[100:103], a[188:191], v[164:167]
 global_load_lds_dwordx4 v240, s[32:33]
 v_mfma_f32_16x16x32_bf16 v[164:167], a[96:99], a[184:187], v[164:167]
 s_add_u32 m0, s52, 57344
 ds_read_b128 a[168:171], v4 offset:0
 v_mfma_f32_16x16x32_bf16 v[168:171], a[152:155], a[184:187], v[168:171]
 s_add_u32 s58, s20, 172032
 ds_read_b128 a[172:175], v5 offset:0
 v_mfma_f32_16x16x32_bf16 v[168:171], a[156:159], a[188:191], v[168:171]
 s_waitcnt lgkmcnt(4)
 ds_read_b64_tr_b16 a[164:165], v12 offset:12288
 v_mfma_f32_16x16x32_bf16 v[180:183], a[156:159], a[196:199], v[180:183]
 s_addc_u32 s59, s21, 0
 ds_read_b64_tr_b16 a[166:167], v12 offset:12800
 v_mfma_f32_16x16x32_bf16 v[180:183], a[152:155], a[192:195], v[180:183]
 global_load_lds_dwordx4 v241, s[58:59]
 v_mfma_f32_16x16x32_bf16 v[176:179], a[96:99], a[192:195], v[176:179]
 s_add_u32 m0, s52, 61440
 ds_read_b128 a[180:183], v5 offset:2048
 v_mfma_f32_16x16x32_bf16 v[176:179], a[100:103], a[196:199], v[176:179]
 ds_read_b128 a[176:179], v4 offset:2048
 v_mfma_f32_16x16x32_bf16 v[172:175], a[44:47], a[196:199], v[172:175]
 v_mfma_f32_16x16x32_bf16 v[172:175], a[40:43], a[192:195], v[172:175]
 s_waitcnt lgkmcnt(2)
 v_mfma_f32_16x16x32_bf16 v[64:67], a[48:51], a[168:171], v[64:67]
 s_waitcnt vmcnt(13)
 v_mfma_f32_16x16x32_bf16 v[64:67], a[52:55], a[172:175], v[64:67]
 s_barrier
 v_mfma_f32_16x16x32_bf16 v[68:71], a[108:111], a[172:175], v[68:71]
 global_load_lds_dwordx4 v242, s[58:59]
 v_mfma_f32_16x16x32_bf16 v[68:71], a[104:107], a[168:171], v[68:71]
 s_add_u32 m0, s52, 65536
 ds_read_b128 a[184:187], v4 offset:4096
 v_mfma_f32_16x16x32_bf16 v[72:75], a[160:163], a[168:171], v[72:75]
 ds_read_b128 a[188:191], v5 offset:4096
 v_mfma_f32_16x16x32_bf16 v[72:75], a[164:167], a[172:175], v[72:75]
 s_waitcnt lgkmcnt(2)
 ds_read_b128 a[196:199], v5 offset:6144
 v_mfma_f32_16x16x32_bf16 v[84:87], a[164:167], a[180:183], v[84:87]
 ds_read_b128 a[192:195], v4 offset:6144
 v_fma_f32 v28, v68, v16, v20
 v_mfma_f32_16x16x32_bf16 v[84:87], a[160:163], a[176:179], v[84:87]
 v_fma_f32 v29, v69, v17, v21
 v_fma_f32 v30, v70, v18, v22
 v_mfma_f32_16x16x32_bf16 v[80:83], a[104:107], a[176:179], v[80:83]
 v_fma_f32 v31, v71, v19, v23
 v_fmac_f32_dpp v28, v64, v16 row_shr:1 row_mask:0xf bank_mask:0xf bound_ctrl:0
 v_mfma_f32_16x16x32_bf16 v[80:83], a[108:111], a[180:183], v[80:83]
 v_fmac_f32_dpp v29, v65, v17 row_shr:1 row_mask:0xf bank_mask:0xf bound_ctrl:0
 v_fmac_f32_dpp v30, v66, v18 row_shr:1 row_mask:0xf bank_mask:0xf bound_ctrl:0
 v_mfma_f32_16x16x32_bf16 v[76:79], a[52:55], a[180:183], v[76:79]
 v_fmac_f32_dpp v31, v67, v19 row_shr:1 row_mask:0xf bank_mask:0xf bound_ctrl:0
 v_fmac_f32_dpp v28, v72, v16 row_shl:1 row_mask:0xf bank_mask:0xf bound_ctrl:0
 v_mfma_f32_16x16x32_bf16 v[76:79], a[48:51], a[176:179], v[76:79]
 s_waitcnt lgkmcnt(1)
 v_fmac_f32_dpp v29, v73, v17 row_shl:1 row_mask:0xf bank_mask:0xf bound_ctrl:0
 v_fmac_f32_dpp v30, v74, v18 row_shl:1 row_mask:0xf bank_mask:0xf bound_ctrl:0
 v_mfma_f32_16x16x32_bf16 v[88:91], a[48:51], a[184:187], v[88:91]
 s_waitcnt vmcnt(13)
 v_fmac_f32_dpp v31, v75, v19 row_shl:1 row_mask:0xf bank_mask:0xf bound_ctrl:0
 v_fma_f32 v32, v80, v16, v20
 v_mfma_f32_16x16x32_bf16 v[88:91], a[52:55], a[188:191], v[88:91]
 s_barrier
 v_mfma_f32_16x16x32_bf16 v[92:95], a[108:111], a[188:191], v[92:95]
 global_load_lds_dwordx4 v243, s[58:59]
 v_mfma_f32_16x16x32_bf16 v[92:95], a[104:107], a[184:187], v[92:95]
 s_add_u32 m0, s52, 69632
 v_exp_f32 v36, v28
 v_mfma_f32_16x16x32_bf16 v[96:99], a[160:163], a[184:187], v[96:99]
 ds_read_b128 a[168:171], v4 offset:8192
 v_fma_f32 v33, v81, v17, v21
 v_mfma_f32_16x16x32_bf16 v[96:99], a[164:167], a[188:191], v[96:99]
 s_waitcnt lgkmcnt(1)
 ds_read_b128 a[172:175], v5 offset:8192
 v_fma_f32 v34, v82, v18, v22
 v_mfma_f32_16x16x32_bf16 v[108:111], a[164:167], a[196:199], v[108:111]
 v_exp_f32 v37, v29
 v_mfma_f32_16x16x32_bf16 v[108:111], a[160:163], a[192:195], v[108:111]
 v_exp_f32 v38, v30
 v_mfma_f32_16x16x32_bf16 v[104:107], a[104:107], a[192:195], v[104:107]
 v_exp_f32 v39, v31
 v_mfma_f32_16x16x32_bf16 v[104:107], a[108:111], a[196:199], v[104:107]
 ds_read_b128 a[180:183], v5 offset:10240
 v_fma_f32 v36, v36, s53, s53
 v_mfma_f32_16x16x32_bf16 v[100:103], a[52:55], a[196:199], v[100:103]
 ds_read_b128 a[176:179], v4 offset:10240
 v_fma_f32 v37, v37, s53, s53
 v_mfma_f32_16x16x32_bf16 v[100:103], a[48:51], a[192:195], v[100:103]
 s_waitcnt lgkmcnt(2)
 v_fma_f32 v38, v38, s53, s53
 v_fma_f32 v39, v39, s53, s53
 v_mfma_f32_16x16x32_bf16 v[112:115], a[48:51], a[168:171], v[112:115]
 s_waitcnt vmcnt(13)
 v_rcp_f32 v36, v36
 v_mfma_f32_16x16x32_bf16 v[112:115], a[52:55], a[172:175], v[112:115]
 s_barrier
 v_mfma_f32_16x16x32_bf16 v[116:119], a[108:111], a[172:175], v[116:119]
 global_load_lds_dwordx4 v244, s[58:59]
 v_mfma_f32_16x16x32_bf16 v[116:119], a[104:107], a[168:171], v[116:119]
 s_add_u32 m0, s52, 77824
 v_rcp_f32 v37, v37
 v_mfma_f32_16x16x32_bf16 v[120:123], a[160:163], a[168:171], v[120:123]
 ds_read_b128 a[184:187], v4 offset:12288
 v_fma_f32 v35, v83, v19, v23
 v_mfma_f32_16x16x32_bf16 v[120:123], a[164:167], a[172:175], v[120:123]
 s_waitcnt lgkmcnt(1)
 ds_read_b128 a[188:191], v5 offset:12288
 v_fmac_f32_dpp v32, v76, v16 row_shr:1 row_mask:0xf bank_mask:0xf bound_ctrl:0
 v_mfma_f32_16x16x32_bf16 v[132:135], a[164:167], a[180:183], v[132:135]
 v_rcp_f32 v38, v38
 v_mfma_f32_16x16x32_bf16 v[132:135], a[160:163], a[176:179], v[132:135]
 v_rcp_f32 v39, v39
 v_mfma_f32_16x16x32_bf16 v[128:131], a[104:107], a[176:179], v[128:131]
 ds_read_b128 a[196:199], v5 offset:14336
 v_mul_f32 v36, v36, v28
 v_mfma_f32_16x16x32_bf16 v[128:131], a[108:111], a[180:183], v[128:131]
 ds_read_b128 a[192:195], v4 offset:14336
 v_mul_f32 v37, v37, v29
 v_mfma_f32_16x16x32_bf16 v[124:127], a[52:55], a[180:183], v[124:127]
 v_mul_f32 v38, v38, v30
 v_mul_f32 v39, v39, v31
 v_mfma_f32_16x16x32_bf16 v[124:127], a[48:51], a[176:179], v[124:127]
 s_waitcnt lgkmcnt(2)
 v_cvt_pk_bf16_f32 v44, v36, v37
 v_cvt_pk_bf16_f32 v45, v38, v39
 v_mfma_f32_16x16x32_bf16 v[136:139], a[48:51], a[184:187], v[136:139]
 s_waitcnt vmcnt(13)
 ds_write_b64 v13, v[44:45] offset:0
 v_mfma_f32_16x16x32_bf16 v[136:139], a[52:55], a[188:191], v[136:139]
 s_barrier
 v_mfma_f32_16x16x32_bf16 v[140:143], a[108:111], a[188:191], v[140:143]
 global_load_lds_dwordx4 v245, s[58:59]
 v_mfma_f32_16x16x32_bf16 v[140:143], a[104:107], a[184:187], v[140:143]
 s_add_u32 m0, s52, 73728
 ds_read_b128 a[168:171], v4 offset:16384
 v_fmac_f32_dpp v33, v77, v17 row_shr:1 row_mask:0xf bank_mask:0xf bound_ctrl:0
 v_mfma_f32_16x16x32_bf16 v[144:147], a[160:163], a[184:187], v[144:147]
 ds_read_b128 a[172:175], v5 offset:16384
 v_fmac_f32_dpp v34, v78, v18 row_shr:1 row_mask:0xf bank_mask:0xf bound_ctrl:0
 v_mfma_f32_16x16x32_bf16 v[144:147], a[164:167], a[188:191], v[144:147]
 s_waitcnt lgkmcnt(3)
 ds_read_b128 a[180:183], v5 offset:18432
 v_fmac_f32_dpp v35, v79, v19 row_shr:1 row_mask:0xf bank_mask:0xf bound_ctrl:0
 v_mfma_f32_16x16x32_bf16 v[156:159], a[164:167], a[196:199], v[156:159]
 ds_read_b128 a[176:179], v4 offset:18432
 v_fmac_f32_dpp v32, v84, v16 row_shl:1 row_mask:0xf bank_mask:0xf bound_ctrl:0
 v_mfma_f32_16x16x32_bf16 v[156:159], a[160:163], a[192:195], v[156:159]
 v_fmac_f32_dpp v33, v85, v17 row_shl:1 row_mask:0xf bank_mask:0xf bound_ctrl:0
 v_fmac_f32_dpp v34, v86, v18 row_shl:1 row_mask:0xf bank_mask:0xf bound_ctrl:0
 v_mfma_f32_16x16x32_bf16 v[152:155], a[104:107], a[192:195], v[152:155]
 v_fmac_f32_dpp v35, v87, v19 row_shl:1 row_mask:0xf bank_mask:0xf bound_ctrl:0
 v_fma_f32 v28, v92, v16, v20
 v_mfma_f32_16x16x32_bf16 v[152:155], a[108:111], a[196:199], v[152:155]
 v_exp_f32 v40, v32
 v_mfma_f32_16x16x32_bf16 v[148:151], a[52:55], a[196:199], v[148:151]
 v_exp_f32 v41, v33
 v_mfma_f32_16x16x32_bf16 v[148:151], a[48:51], a[192:195], v[148:151]
 s_waitcnt lgkmcnt(1)
 v_exp_f32 v42, v34
 v_mfma_f32_16x16x32_bf16 v[160:163], a[48:51], a[168:171], v[160:163]
 s_waitcnt vmcnt(12)
 v_exp_f32 v43, v35
 v_mfma_f32_16x16x32_bf16 v[160:163], a[52:55], a[172:175], v[160:163]
 s_barrier
 v_mfma_f32_16x16x32_bf16 v[164:167], a[108:111], a[172:175], v[164:167]
 global_load_lds_dwordx4 v246, s[58:59]
 v_mfma_f32_16x16x32_bf16 v[164:167], a[104:107], a[168:171], v[164:167]
 s_add_u32 m0, s52, 81920
 ds_read_b128 a[184:187], v4 offset:20480
 v_fma_f32 v40, v40, s53, s53
 v_mfma_f32_16x16x32_bf16 v[168:171], a[160:163], a[168:171], v[168:171]
 s_add_u32 s32, s20, 229376
 ds_read_b128 a[188:191], v5 offset:20480
 v_fma_f32 v41, v41, s53, s53
 v_mfma_f32_16x16x32_bf16 v[168:171], a[164:167], a[172:175], v[168:171]
 s_waitcnt lgkmcnt(2)
 ds_read_b128 a[192:195], v4 offset:24576
 v_fma_f32 v42, v42, s53, s53
 v_mfma_f32_16x16x32_bf16 v[180:183], a[164:167], a[180:183], v[180:183]
 s_addc_u32 s33, s21, 0
 ds_read_b128 a[196:199], v5 offset:24576
 v_fma_f32 v43, v43, s53, s53
 v_mfma_f32_16x16x32_bf16 v[180:183], a[160:163], a[176:179], v[180:183]
 global_load_lds_dwordx4 v240, s[32:33]
 v_mfma_f32_16x16x32_bf16 v[176:179], a[104:107], a[176:179], v[176:179]
 s_add_u32 m0, s52, 86016
 v_rcp_f32 v40, v40
 v_mfma_f32_16x16x32_bf16 v[176:179], a[108:111], a[180:183], v[176:179]
 s_add_u32 s58, s20, 200704
 v_rcp_f32 v41, v41
 v_mfma_f32_16x16x32_bf16 v[172:175], a[52:55], a[180:183], v[172:175]
 s_addc_u32 s59, s21, 0
 v_rcp_f32 v42, v42
 v_mfma_f32_16x16x32_bf16 v[172:175], a[48:51], a[176:179], v[172:175]
 s_waitcnt lgkmcnt(1)
 v_rcp_f32 v43, v43
 v_mfma_f32_16x16x32_bf16 v[184:187], a[0:3], a[184:187], 0
 s_waitcnt vmcnt(12)
 v_mul_f32 v40, v40, v32
 v_mul_f32 v41, v41, v33
 v_mfma_f32_16x16x32_bf16 v[184:187], a[4:7], a[188:191], v[184:187]
 s_barrier
 v_mfma_f32_16x16x32_bf16 v[188:191], a[60:63], a[188:191], 0
 global_load_lds_dwordx4 v241, s[58:59]
 v_mfma_f32_16x16x32_bf16 v[188:191], a[56:59], a[184:187], v[188:191]
 s_add_u32 m0, s52, 90112
 ds_read_b128 a[168:171], v4 offset:28672
 v_mul_f32 v42, v42, v34
 v_mfma_f32_16x16x32_bf16 v[192:195], a[112:115], a[184:187], 0
 ds_read_b128 a[172:175], v5 offset:28672
 v_mul_f32 v43, v43, v35
 v_mfma_f32_16x16x32_bf16 v[192:195], a[116:119], a[188:191], v[192:195]
 s_waitcnt lgkmcnt(2)
 ds_read_b128 a[176:179], v4 offset:32768
 v_cvt_pk_bf16_f32 v46, v40, v41
 v_mfma_f32_16x16x32_bf16 v[192:195], a[120:123], a[192:195], v[192:195]
 global_load_lds_dwordx4 v242, s[58:59]
 v_mfma_f32_16x16x32_bf16 v[192:195], a[124:127], a[196:199], v[192:195]
 s_add_u32 m0, s52, 94208
 ds_read_b128 a[180:183], v5 offset:32768
 v_cvt_pk_bf16_f32 v47, v42, v43
 v_mfma_f32_16x16x32_bf16 v[188:191], a[68:71], a[196:199], v[188:191]
 ds_write_b64 v13, v[46:47] offset:2048
 v_mfma_f32_16x16x32_bf16 v[188:191], a[64:67], a[192:195], v[188:191]
 v_fma_f32 v29, v93, v17, v21
 v_fma_f32 v30, v94, v18, v22
 v_mfma_f32_16x16x32_bf16 v[184:187], a[8:11], a[192:195], v[184:187]
 v_fma_f32 v31, v95, v19, v23
 v_fmac_f32_dpp v28, v88, v16 row_shr:1 row_mask:0xf bank_mask:0xf bound_ctrl:0
 v_mfma_f32_16x16x32_bf16 v[184:187], a[12:15], a[196:199], v[184:187]
 s_waitcnt lgkmcnt(2)
 v_fmac_f32_dpp v29, v89, v17 row_shr:1 row_mask:0xf bank_mask:0xf bound_ctrl:0
 v_fmac_f32_dpp v30, v90, v18 row_shr:1 row_mask:0xf bank_mask:0xf bound_ctrl:0
 v_mfma_f32_16x16x32_bf16 v[184:187], a[16:19], a[168:171], v[184:187]
 s_waitcnt vmcnt(12) lgkmcnt(0)
 v_fmac_f32_dpp v31, v91, v19 row_shr:1 row_mask:0xf bank_mask:0xf bound_ctrl:0
 v_fmac_f32_dpp v28, v96, v16 row_shl:1 row_mask:0xf bank_mask:0xf bound_ctrl:0
 v_mfma_f32_16x16x32_bf16 v[184:187], a[20:23], a[172:175], v[184:187]
 s_barrier
 v_mfma_f32_16x16x32_bf16 v[188:191], a[76:79], a[172:175], v[188:191]
 global_load_lds_dwordx4 v243, s[58:59]
 v_mfma_f32_16x16x32_bf16 v[188:191], a[72:75], a[168:171], v[188:191]
 s_add_u32 m0, s52, 98304
 ds_read_b128 a[184:187], v4 offset:36864
 v_fmac_f32_dpp v29, v97, v17 row_shl:1 row_mask:0xf bank_mask:0xf bound_ctrl:0
 v_mfma_f32_16x16x32_bf16 v[192:195], a[128:131], a[168:171], v[192:195]
 ds_read_b128 a[188:191], v5 offset:36864
 v_fmac_f32_dpp v30, v98, v18 row_shl:1 row_mask:0xf bank_mask:0xf bound_ctrl:0
 v_mfma_f32_16x16x32_bf16 v[192:195], a[132:135], a[172:175], v[192:195]
 global_load_lds_dwordx4 v244, s[58:59]
 v_mfma_f32_16x16x32_bf16 v[192:195], a[136:139], a[176:179], v[192:195]
 s_add_u32 m0, s52, 102400
 ds_read_b128 a[192:195], v4 offset:40960
 v_fmac_f32_dpp v31, v99, v19 row_shl:1 row_mask:0xf bank_mask:0xf bound_ctrl:0
 v_mfma_f32_16x16x32_bf16 v[192:195], a[140:143], a[180:183], v[192:195]
 v_exp_f32 v36, v28
 v_mfma_f32_16x16x32_bf16 v[188:191], a[84:87], a[180:183], v[188:191]
 v_exp_f32 v37, v29
 v_mfma_f32_16x16x32_bf16 v[188:191], a[80:83], a[176:179], v[188:191]
 v_exp_f32 v38, v30
 v_mfma_f32_16x16x32_bf16 v[184:187], a[24:27], a[176:179], v[184:187]
 v_exp_f32 v39, v31
 v_mfma_f32_16x16x32_bf16 v[184:187], a[28:31], a[180:183], v[184:187]
 s_waitcnt lgkmcnt(0)
 ds_read_b128 a[196:199], v5 offset:40960
 v_fma_f32 v36, v36, s53, s53
 v_mfma_f32_16x16x32_bf16 v[184:187], a[32:35], a[184:187], v[184:187]
 s_waitcnt vmcnt(13)
 ds_read_b128 v[48:51], v14 offset:0
 v_fma_f32 v37, v37, s53, s53
 v_mfma_f32_16x16x32_bf16 v[184:187], a[36:39], a[188:191], v[184:187]
 s_barrier
 v_mfma_f32_16x16x32_bf16 v[188:191], a[92:95], a[188:191], v[188:191]
 global_load_lds_dwordx4 v245, s[58:59]
 v_mfma_f32_16x16x32_bf16 v[188:191], a[88:91], a[184:187], v[188:191]
 s_add_u32 m0, s52, 106496
 ds_read_b128 a[168:171], v4 offset:45056
 v_fma_f32 v38, v38, s53, s53
 v_mfma_f32_16x16x32_bf16 v[192:195], a[144:147], a[184:187], v[192:195]
 s_add_u32 s61, s51, 0
 ds_read_b128 a[172:175], v5 offset:45056
 v_fma_f32 v39, v39, s53, s53
 v_mfma_f32_16x16x32_bf16 v[192:195], a[148:151], a[188:191], v[192:195]
 s_waitcnt lgkmcnt(3)
 v_rcp_f32 v36, v36
 v_mfma_f32_16x16x32_bf16 v[192:195], a[152:155], a[192:195], v[192:195]
 s_waitcnt lgkmcnt(2)
 v_rcp_f32 v37, v37
 v_mfma_f32_16x16x32_bf16 v[192:195], a[156:159], a[196:199], v[192:195]
 buffer_store_dwordx4 v[48:51], v3, s[28:31], s61 offen sc1
 v_mfma_f32_16x16x32_bf16 v[188:191], a[100:103], a[196:199], v[188:191]
 v_rcp_f32 v38, v38
 v_mfma_f32_16x16x32_bf16 v[188:191], a[96:99], a[192:195], v[188:191]
 v_rcp_f32 v39, v39
 v_mfma_f32_16x16x32_bf16 v[184:187], a[40:43], a[192:195], v[184:187]
 ds_read_b128 a[176:179], v4 offset:22528
 v_mul_f32 v36, v36, v28
 v_mfma_f32_16x16x32_bf16 v[184:187], a[44:47], a[196:199], v[184:187]
 s_waitcnt lgkmcnt(1)
 ds_read_b128 a[180:183], v5 offset:22528
 v_mul_f32 v37, v37, v29
 v_mfma_f32_16x16x32_bf16 v[184:187], a[48:51], a[168:171], v[184:187]
 ds_read_b128 a[184:187], v4 offset:26624
 v_mul_f32 v38, v38, v30
 v_mfma_f32_16x16x32_bf16 v[184:187], a[52:55], a[172:175], v[184:187]
 ds_read_b128 a[188:191], v5 offset:26624
 v_mul_f32 v39, v39, v31
 v_mfma_f32_16x16x32_bf16 v[188:191], a[108:111], a[172:175], v[188:191]
 ds_read_b128 a[192:195], v4 offset:30720
 v_cvt_pk_bf16_f32 v44, v36, v37
 v_mfma_f32_16x16x32_bf16 v[188:191], a[104:107], a[168:171], v[188:191]
 ds_read_b128 a[196:199], v5 offset:30720
 v_cvt_pk_bf16_f32 v45, v38, v39
 v_mfma_f32_16x16x32_bf16 v[192:195], a[160:163], a[168:171], v[192:195]
 ds_write_b64 v13, v[44:45] offset:4096
 v_mfma_f32_16x16x32_bf16 v[192:195], a[164:167], a[172:175], v[192:195]
 s_waitcnt lgkmcnt(4)
 v_fma_f32 v32, v104, v16, v20
 v_fma_f32 v33, v105, v17, v21
 v_mfma_f32_16x16x32_bf16 v[196:199], a[0:3], a[176:179], 0
 ds_read_b128 a[168:171], v4 offset:34816
 v_fma_f32 v34, v106, v18, v22
 v_mfma_f32_16x16x32_bf16 v[196:199], a[4:7], a[180:183], v[196:199]
 ds_read_b128 a[172:175], v5 offset:34816
 v_fma_f32 v35, v107, v19, v23
 v_mfma_f32_16x16x32_bf16 v[200:203], a[60:63], a[180:183], 0
 global_load_lds_dwordx4 v246, s[58:59]
 v_mfma_f32_16x16x32_bf16 v[200:203], a[56:59], a[176:179], v[200:203]
 s_add_u32 m0, s52, 110592
 v_fmac_f32_dpp v32, v100, v16 row_shr:1 row_mask:0xf bank_mask:0xf bound_ctrl:0
 v_fmac_f32_dpp v33, v101, v17 row_shr:1 row_mask:0xf bank_mask:0xf bound_ctrl:0
 v_mfma_f32_16x16x32_bf16 v[204:207], a[112:115], a[176:179], 0
 s_add_u32 s32, s20, 258048
 v_fmac_f32_dpp v34, v102, v18 row_shr:1 row_mask:0xf bank_mask:0xf bound_ctrl:0
 v_fmac_f32_dpp v35, v103, v19 row_shr:1 row_mask:0xf bank_mask:0xf bound_ctrl:0
 v_mfma_f32_16x16x32_bf16 v[204:207], a[116:119], a[180:183], v[204:207]
 s_addc_u32 s33, s21, 0
 v_fmac_f32_dpp v32, v108, v16 row_shl:1 row_mask:0xf bank_mask:0xf bound_ctrl:0
 v_fmac_f32_dpp v33, v109, v17 row_shl:1 row_mask:0xf bank_mask:0xf bound_ctrl:0
 v_mfma_f32_16x16x32_bf16 v[204:207], a[120:123], a[184:187], v[204:207]
 s_waitcnt lgkmcnt(3)
 ds_read_b128 a[176:179], v4 offset:38912
 v_fmac_f32_dpp v34, v110, v18 row_shl:1 row_mask:0xf bank_mask:0xf bound_ctrl:0
 v_mfma_f32_16x16x32_bf16 v[204:207], a[124:127], a[188:191], v[204:207]
 global_load_lds_dwordx4 v240, s[32:33]
 v_mfma_f32_16x16x32_bf16 v[200:203], a[68:71], a[188:191], v[200:203]
 s_add_u32 m0, s52, 114688
 ds_read_b128 a[180:183], v5 offset:38912
 v_fmac_f32_dpp v35, v111, v19 row_shl:1 row_mask:0xf bank_mask:0xf bound_ctrl:0
 v_mfma_f32_16x16x32_bf16 v[200:203], a[64:67], a[184:187], v[200:203]
 s_add_u32 s58, s20, 229376
 v_exp_f32 v40, v32
 v_mfma_f32_16x16x32_bf16 v[196:199], a[8:11], a[184:187], v[196:199]
 s_addc_u32 s59, s21, 0
 v_exp_f32 v41, v33
 v_mfma_f32_16x16x32_bf16 v[196:199], a[12:15], a[188:191], v[196:199]
 v_exp_f32 v42, v34
 v_mfma_f32_16x16x32_bf16 v[196:199], a[16:19], a[192:195], v[196:199]
 v_exp_f32 v43, v35
 v_mfma_f32_16x16x32_bf16 v[196:199], a[20:23], a[196:199], v[196:199]
 ds_read_b128 a[184:187], v4 offset:43008
 v_fma_f32 v40, v40, s53, s53
 v_mfma_f32_16x16x32_bf16 v[200:203], a[76:79], a[196:199], v[200:203]
 ds_read_b128 a[188:191], v5 offset:43008
 v_fma_f32 v41, v41, s53, s53
 v_mfma_f32_16x16x32_bf16 v[200:203], a[72:75], a[192:195], v[200:203]
 v_fma_f32 v42, v42, s53, s53
 v_fma_f32 v43, v43, s53, s53
 v_mfma_f32_16x16x32_bf16 v[204:207], a[128:131], a[192:195], v[204:207]
 v_rcp_f32 v40, v40
 v_mfma_f32_16x16x32_bf16 v[204:207], a[132:135], a[196:199], v[204:207]
 s_waitcnt lgkmcnt(3)
 v_rcp_f32 v41, v41
 v_mfma_f32_16x16x32_bf16 v[204:207], a[136:139], a[168:171], v[204:207]
 v_rcp_f32 v42, v42
 v_mfma_f32_16x16x32_bf16 v[204:207], a[140:143], a[172:175], v[204:207]
 v_rcp_f32 v43, v43
 v_mfma_f32_16x16x32_bf16 v[200:203], a[84:87], a[172:175], v[200:203]
 s_waitcnt vmcnt(9)
 ds_read_b128 a[192:195], v4 offset:47104
 v_mul_f32 v40, v40, v32
 v_mfma_f32_16x16x32_bf16 v[200:203], a[80:83], a[168:171], v[200:203]
 s_barrier
 v_mfma_f32_16x16x32_bf16 v[196:199], a[24:27], a[168:171], v[196:199]
 ds_read_b128 a[196:199], v5 offset:47104
 v_mul_f32 v41, v41, v33
 v_mfma_f32_16x16x32_bf16 v[196:199], a[28:31], a[172:175], v[196:199]
 v_mul_f32 v42, v42, v34
 v_mul_f32 v43, v43, v35
 v_mfma_f32_16x16x32_bf16 v[196:199], a[32:35], a[176:179], v[196:199]
 s_waitcnt lgkmcnt(2)
 ds_read_b128 a[168:171], v4 offset:49152
 v_cvt_pk_bf16_f32 v46, v40, v41
 v_mfma_f32_16x16x32_bf16 v[196:199], a[36:39], a[180:183], v[196:199]
 ds_read_b128 a[172:175], v5 offset:49152
 v_cvt_pk_bf16_f32 v47, v42, v43
 v_mfma_f32_16x16x32_bf16 v[200:203], a[92:95], a[180:183], v[200:203]
 ds_write_b64 v13, v[46:47] offset:6144
 v_mfma_f32_16x16x32_bf16 v[200:203], a[88:91], a[176:179], v[200:203]
 v_fma_f32 v28, v116, v16, v20
 v_fma_f32 v29, v117, v17, v21
 v_mfma_f32_16x16x32_bf16 v[204:207], a[144:147], a[176:179], v[204:207]
 v_fma_f32 v30, v118, v18, v22
 v_fma_f32 v31, v119, v19, v23
 v_mfma_f32_16x16x32_bf16 v[204:207], a[148:151], a[180:183], v[204:207]
 v_fmac_f32_dpp v28, v112, v16 row_shr:1 row_mask:0xf bank_mask:0xf bound_ctrl:0
 v_fmac_f32_dpp v29, v113, v17 row_shr:1 row_mask:0xf bank_mask:0xf bound_ctrl:0
 v_mfma_f32_16x16x32_bf16 v[204:207], a[152:155], a[184:187], v[204:207]
 ds_read_b128 a[176:179], v4 offset:57344
 v_fmac_f32_dpp v30, v114, v18 row_shr:1 row_mask:0xf bank_mask:0xf bound_ctrl:0
 v_mfma_f32_16x16x32_bf16 v[204:207], a[156:159], a[188:191], v[204:207]
 ds_read_b128 a[180:183], v5 offset:57344
 v_fmac_f32_dpp v31, v115, v19 row_shr:1 row_mask:0xf bank_mask:0xf bound_ctrl:0
 v_mfma_f32_16x16x32_bf16 v[200:203], a[100:103], a[188:191], v[200:203]
 v_fmac_f32_dpp v28, v120, v16 row_shl:1 row_mask:0xf bank_mask:0xf bound_ctrl:0
 v_fmac_f32_dpp v29, v121, v17 row_shl:1 row_mask:0xf bank_mask:0xf bound_ctrl:0
 v_mfma_f32_16x16x32_bf16 v[200:203], a[96:99], a[184:187], v[200:203]
 v_fmac_f32_dpp v30, v122, v18 row_shl:1 row_mask:0xf bank_mask:0xf bound_ctrl:0
 v_fmac_f32_dpp v31, v123, v19 row_shl:1 row_mask:0xf bank_mask:0xf bound_ctrl:0
 v_mfma_f32_16x16x32_bf16 v[196:199], a[40:43], a[184:187], v[196:199]
 v_exp_f32 v36, v28
 v_mfma_f32_16x16x32_bf16 v[196:199], a[44:47], a[188:191], v[196:199]
 s_waitcnt lgkmcnt(4)
 v_exp_f32 v37, v29
 v_mfma_f32_16x16x32_bf16 v[196:199], a[48:51], a[192:195], v[196:199]
 v_exp_f32 v38, v30
 v_mfma_f32_16x16x32_bf16 v[196:199], a[52:55], a[196:199], v[196:199]
 v_exp_f32 v39, v31
 v_mfma_f32_16x16x32_bf16 v[200:203], a[108:111], a[196:199], v[200:203]
 ds_read_b128 a[184:187], v4 offset:61440
 v_fma_f32 v36, v36, s53, s53
 v_mfma_f32_16x16x32_bf16 v[200:203], a[104:107], a[192:195], v[200:203]
 ds_read_b128 a[188:191], v5 offset:61440
 v_fma_f32 v37, v37, s53, s53
 v_mfma_f32_16x16x32_bf16 v[204:207], a[160:163], a[192:195], v[204:207]
 global_load_lds_dwordx4 v241, s[58:59]
 v_mfma_f32_16x16x32_bf16 v[204:207], a[164:167], a[196:199], v[204:207]
 s_add_u32 m0, s52, 118784
 v_fma_f32 v38, v38, s53, s53
 v_fma_f32 v39, v39, s53, s53
 v_mfma_f32_16x16x32_bf16 v[64:67], a[0:3], a[168:171], 0
 s_waitcnt lgkmcnt(2)
 v_rcp_f32 v36, v36
 v_mfma_f32_16x16x32_bf16 v[64:67], a[4:7], a[172:175], v[64:67]
 v_rcp_f32 v37, v37
 v_mfma_f32_16x16x32_bf16 v[68:71], a[60:63], a[172:175], 0
 v_rcp_f32 v38, v38
 v_mfma_f32_16x16x32_bf16 v[68:71], a[56:59], a[168:171], v[68:71]
 v_rcp_f32 v39, v39
 v_mfma_f32_16x16x32_bf16 v[72:75], a[112:115], a[168:171], 0
 global_load_lds_dwordx4 v242, s[58:59]
 v_mfma_f32_16x16x32_bf16 v[72:75], a[116:119], a[172:175], v[72:75]
 s_add_u32 m0, s52, 122880
 ds_read_b128 a[192:195], v6 offset:0
 v_mul_f32 v36, v36, v28
 v_mfma_f32_16x16x32_bf16 v[72:75], a[120:123], a[176:179], v[72:75]
L_pad3:
 s_cbranch_execz L_pad7
 ds_read_b128 a[196:199], v7 offset:0
 v_mul_f32 v37, v37, v29
 v_mfma_f32_16x16x32_bf16 v[72:75], a[124:127], a[180:183], v[72:75]
 ds_read_b128 a[168:171], v6 offset:4096
 v_mul_f32 v38, v38, v30
 v_mfma_f32_16x16x32_bf16 v[68:71], a[68:71], a[180:183], v[68:71]
 ds_read_b128 a[172:175], v7 offset:4096
 v_mul_f32 v39, v39, v31
 v_mfma_f32_16x16x32_bf16 v[68:71], a[64:67], a[176:179], v[68:71]
 v_cvt_pk_bf16_f32 v44, v36, v37
 v_cvt_pk_bf16_f32 v45, v38, v39
 v_mfma_f32_16x16x32_bf16 v[64:67], a[8:11], a[176:179], v[64:67]
 global_load_lds_dwordx4 v243, s[58:59]
 v_mfma_f32_16x16x32_bf16 v[64:67], a[12:15], a[180:183], v[64:67]
 s_waitcnt lgkmcnt(3)
 ds_write_b64 v13, v[44:45] offset:8192
 v_mfma_f32_16x16x32_bf16 v[64:67], a[16:19], a[184:187], v[64:67]
 s_add_u32 m0, s52, 126976
 ds_read_b128 a[176:179], v6 offset:12288
 v_fma_f32 v32, v128, v16, v20
 v_mfma_f32_16x16x32_bf16 v[64:67], a[20:23], a[188:191], v[64:67]
 ds_read_b128 a[180:183], v7 offset:12288
 v_fma_f32 v33, v129, v17, v21
 v_mfma_f32_16x16x32_bf16 v[68:71], a[76:79], a[188:191], v[68:71]
 v_fma_f32 v34, v130, v18, v22
 v_fma_f32 v35, v131, v19, v23
 v_mfma_f32_16x16x32_bf16 v[68:71], a[72:75], a[184:187], v[68:71]
 v_fmac_f32_dpp v32, v124, v16 row_shr:1 row_mask:0xf bank_mask:0xf bound_ctrl:0
 v_fmac_f32_dpp v33, v125, v17 row_shr:1 row_mask:0xf bank_mask:0xf bound_ctrl:0
 v_mfma_f32_16x16x32_bf16 v[72:75], a[128:131], a[184:187], v[72:75]
 global_load_lds_dwordx4 v244, s[58:59]
 v_mfma_f32_16x16x32_bf16 v[72:75], a[132:135], a[188:191], v[72:75]
 s_add_u32 m0, s52, 131072
 v_fmac_f32_dpp v34, v126, v18 row_shr:1 row_mask:0xf bank_mask:0xf bound_ctrl:0
 v_fmac_f32_dpp v35, v127, v19 row_shr:1 row_mask:0xf bank_mask:0xf bound_ctrl:0
 v_mfma_f32_16x16x32_bf16 v[72:75], a[136:139], a[192:195], v[72:75]
 s_waitcnt lgkmcnt(3)
 ds_read_b128 a[184:187], v6 offset:8192
 v_fmac_f32_dpp v32, v132, v16 row_shl:1 row_mask:0xf bank_mask:0xf bound_ctrl:0
 v_mfma_f32_16x16x32_bf16 v[72:75], a[140:143], a[196:199], v[72:75]
 ds_read_b128 a[188:191], v7 offset:8192
 v_fmac_f32_dpp v33, v133, v17 row_shl:1 row_mask:0xf bank_mask:0xf bound_ctrl:0
 v_mfma_f32_16x16x32_bf16 v[68:71], a[84:87], a[196:199], v[68:71]
 v_fmac_f32_dpp v34, v134, v18 row_shl:1 row_mask:0xf bank_mask:0xf bound_ctrl:0
 v_fmac_f32_dpp v35, v135, v19 row_shl:1 row_mask:0xf bank_mask:0xf bound_ctrl:0
 v_mfma_f32_16x16x32_bf16 v[68:71], a[80:83], a[192:195], v[68:71]
 v_exp_f32 v40, v32
 v_mfma_f32_16x16x32_bf16 v[64:67], a[24:27], a[192:195], v[64:67]
 global_load_lds_dwordx4 v245, s[58:59]
 v_mfma_f32_16x16x32_bf16 v[64:67], a[28:31], a[196:199], v[64:67]
 s_add_u32 m0, s52, 135168
 v_exp_f32 v41, v33
 v_mfma_f32_16x16x32_bf16 v[64:67], a[32:35], a[168:171], v[64:67]
 v_exp_f32 v42, v34
 v_mfma_f32_16x16x32_bf16 v[64:67], a[36:39], a[172:175], v[64:67]
 v_exp_f32 v43, v35
 v_mfma_f32_16x16x32_bf16 v[68:71], a[92:95], a[172:175], v[68:71]
 ds_read_b128 a[192:195], v4 offset:51200
 v_fma_f32 v40, v40, s53, s53
 v_mfma_f32_16x16x32_bf16 v[68:71], a[88:91], a[168:171], v[68:71]
 ds_read_b128 a[196:199], v5 offset:51200
 v_fma_f32 v41, v41, s53, s53
 v_mfma_f32_16x16x32_bf16 v[72:75], a[144:147], a[168:171], v[72:75]
 global_load_lds_dwordx4 v246, s[58:59]
 v_mfma_f32_16x16x32_bf16 v[72:75], a[148:151], a[172:175], v[72:75]
 s_waitcnt lgkmcnt(3)
 v_fma_f32 v42, v42, s53, s53
 v_fma_f32 v43, v43, s53, s53
 v_mfma_f32_16x16x32_bf16 v[72:75], a[152:155], a[176:179], v[72:75]
 s_add_u32 m0, s52, 139264
 v_rcp_f32 v40, v40
 v_mfma_f32_16x16x32_bf16 v[72:75], a[156:159], a[180:183], v[72:75]
 s_add_u32 s32, s20, 286720
 v_rcp_f32 v41, v41
 v_mfma_f32_16x16x32_bf16 v[68:71], a[100:103], a[180:183], v[68:71]
 s_addc_u32 s33, s21, 0
 v_rcp_f32 v42, v42
 v_mfma_f32_16x16x32_bf16 v[68:71], a[96:99], a[176:179], v[68:71]
 v_rcp_f32 v43, v43
 v_mfma_f32_16x16x32_bf16 v[64:67], a[40:43], a[176:179], v[64:67]
 global_load_lds_dwordx4 v240, s[32:33]
 v_mfma_f32_16x16x32_bf16 v[64:67], a[44:47], a[180:183], v[64:67]
 s_waitcnt lgkmcnt(1)
 ds_read_b128 a[168:171], v4 offset:59392
 v_mul_f32 v40, v40, v32
 v_mfma_f32_16x16x32_bf16 v[64:67], a[48:51], a[184:187], v[64:67]
 s_add_u32 m0, s52, 143360
 ds_read_b128 a[172:175], v5 offset:59392
 v_mul_f32 v41, v41, v33
 v_mfma_f32_16x16x32_bf16 v[64:67], a[52:55], a[188:191], v[64:67]
 s_add_u32 s58, s20, 258048
 ds_read_b128 a[176:179], v4 offset:63488
 v_mul_f32 v42, v42, v34
 v_mfma_f32_16x16x32_bf16 v[68:71], a[108:111], a[188:191], v[68:71]
 s_addc_u32 s59, s21, 0
 ds_read_b128 a[180:183], v5 offset:63488
 v_mul_f32 v43, v43, v35
 v_mfma_f32_16x16x32_bf16 v[68:71], a[104:107], a[184:187], v[68:71]
 v_cvt_pk_bf16_f32 v46, v40, v41
 v_cvt_pk_bf16_f32 v47, v42, v43
 v_mfma_f32_16x16x32_bf16 v[72:75], a[160:163], a[184:187], v[72:75]
 ds_write_b64 v13, v[46:47] offset:10240
 v_mfma_f32_16x16x32_bf16 v[72:75], a[164:167], a[188:191], v[72:75]
 v_fma_f32 v28, v140, v16, v20
 v_fma_f32 v29, v141, v17, v21
 v_mfma_f32_16x16x32_bf16 v[76:79], a[0:3], a[192:195], 0
 s_waitcnt lgkmcnt(3)
 ds_read_b128 a[184:187], v6 offset:2048
 v_fma_f32 v30, v142, v18, v22
 v_mfma_f32_16x16x32_bf16 v[76:79], a[4:7], a[196:199], v[76:79]
 ds_read_b128 a[188:191], v7 offset:2048
 v_fma_f32 v31, v143, v19, v23
 v_mfma_f32_16x16x32_bf16 v[80:83], a[60:63], a[196:199], 0
 v_fmac_f32_dpp v28, v136, v16 row_shr:1 row_mask:0xf bank_mask:0xf bound_ctrl:0
 v_fmac_f32_dpp v29, v137, v17 row_shr:1 row_mask:0xf bank_mask:0xf bound_ctrl:0
 v_mfma_f32_16x16x32_bf16 v[80:83], a[56:59], a[192:195], v[80:83]
 v_fmac_f32_dpp v30, v138, v18 row_shr:1 row_mask:0xf bank_mask:0xf bound_ctrl:0
 v_fmac_f32_dpp v31, v139, v19 row_shr:1 row_mask:0xf bank_mask:0xf bound_ctrl:0
 v_mfma_f32_16x16x32_bf16 v[84:87], a[112:115], a[192:195], 0
 v_fmac_f32_dpp v28, v144, v16 row_shl:1 row_mask:0xf bank_mask:0xf bound_ctrl:0
 v_fmac_f32_dpp v29, v145, v17 row_shl:1 row_mask:0xf bank_mask:0xf bound_ctrl:0
 v_mfma_f32_16x16x32_bf16 v[84:87], a[116:119], a[196:199], v[84:87]
 v_fmac_f32_dpp v30, v146, v18 row_shl:1 row_mask:0xf bank_mask:0xf bound_ctrl:0
 v_fmac_f32_dpp v31, v147, v19 row_shl:1 row_mask:0xf bank_mask:0xf bound_ctrl:0
 v_mfma_f32_16x16x32_bf16 v[84:87], a[120:123], a[168:171], v[84:87]
 v_exp_f32 v36, v28
 v_mfma_f32_16x16x32_bf16 v[84:87], a[124:127], a[172:175], v[84:87]
 v_exp_f32 v37, v29
 v_mfma_f32_16x16x32_bf16 v[80:83], a[68:71], a[172:175], v[80:83]
 v_exp_f32 v38, v30
 v_mfma_f32_16x16x32_bf16 v[80:83], a[64:67], a[168:171], v[80:83]
 v_exp_f32 v39, v31
 v_mfma_f32_16x16x32_bf16 v[76:79], a[8:11], a[168:171], v[76:79]
 ds_read_b128 a[192:195], v6 offset:6144
 v_fma_f32 v36, v36, s53, s53
 v_mfma_f32_16x16x32_bf16 v[76:79], a[12:15], a[172:175], v[76:79]
 s_waitcnt lgkmcnt(2)
 ds_read_b128 a[196:199], v7 offset:6144
 v_fma_f32 v37, v37, s53, s53
 v_mfma_f32_16x16x32_bf16 v[76:79], a[16:19], a[176:179], v[76:79]
 ds_read_b128 a[168:171], v6 offset:14336
 v_fma_f32 v38, v38, s53, s53
 v_mfma_f32_16x16x32_bf16 v[76:79], a[20:23], a[180:183], v[76:79]
 ds_read_b128 a[172:175], v7 offset:14336
 v_fma_f32 v39, v39, s53, s53
 v_mfma_f32_16x16x32_bf16 v[80:83], a[76:79], a[180:183], v[80:83]
 v_rcp_f32 v36, v36
 v_mfma_f32_16x16x32_bf16 v[80:83], a[72:75], a[176:179], v[80:83]
 v_rcp_f32 v37, v37
 v_mfma_f32_16x16x32_bf16 v[84:87], a[128:131], a[176:179], v[84:87]
 v_rcp_f32 v38, v38
 v_mfma_f32_16x16x32_bf16 v[84:87], a[132:135], a[180:183], v[84:87]
 v_rcp_f32 v39, v39
 v_mfma_f32_16x16x32_bf16 v[84:87], a[136:139], a[184:187], v[84:87]
 s_waitcnt lgkmcnt(2)
 ds_read_b128 a[176:179], v6 offset:10240
 v_mul_f32 v36, v36, v28
 v_mfma_f32_16x16x32_bf16 v[84:87], a[140:143], a[188:191], v[84:87]
 ds_read_b128 a[180:183], v7 offset:10240
 v_mul_f32 v37, v37, v29
 v_mfma_f32_16x16x32_bf16 v[80:83], a[84:87], a[188:191], v[80:83]
 s_waitcnt vmcnt(8)
 v_mul_f32 v38, v38, v30
 v_mul_f32 v39, v39, v31
 v_mfma_f32_16x16x32_bf16 v[80:83], a[80:83], a[184:187], v[80:83]
 s_barrier
 v_mfma_f32_16x16x32_bf16 v[76:79], a[24:27], a[184:187], v[76:79]
 ds_read_b128 v[52:55], v14 offset:4096
 v_cvt_pk_bf16_f32 v44, v36, v37
 v_mfma_f32_16x16x32_bf16 v[76:79], a[28:31], a[188:191], v[76:79]
 s_add_u32 s61, s51, 28672
 v_cvt_pk_bf16_f32 v45, v38, v39
 v_fma_f32 v32, v152, v16, v20
 v_mfma_f32_16x16x32_bf16 v[76:79], a[32:35], a[192:195], v[76:79]
 ds_write_b64 v13, v[44:45] offset:12288
 v_mfma_f32_16x16x32_bf16 v[76:79], a[36:39], a[196:199], v[76:79]
 ds_read_b128 a[184:187], v4 offset:53248
 v_fma_f32 v33, v153, v17, v21
 v_mfma_f32_16x16x32_bf16 v[80:83], a[92:95], a[196:199], v[80:83]
 ds_read_b128 a[188:191], v5 offset:53248
 v_fma_f32 v34, v154, v18, v22
 v_mfma_f32_16x16x32_bf16 v[80:83], a[88:91], a[192:195], v[80:83]
 v_fma_f32 v35, v155, v19, v23
 v_fmac_f32_dpp v32, v148, v16 row_shr:1 row_mask:0xf bank_mask:0xf bound_ctrl:0
 v_mfma_f32_16x16x32_bf16 v[84:87], a[144:147], a[192:195], v[84:87]
 s_waitcnt lgkmcnt(3)
 v_fmac_f32_dpp v33, v149, v17 row_shr:1 row_mask:0xf bank_mask:0xf bound_ctrl:0
 v_fmac_f32_dpp v34, v150, v18 row_shr:1 row_mask:0xf bank_mask:0xf bound_ctrl:0
 v_mfma_f32_16x16x32_bf16 v[84:87], a[148:151], a[196:199], v[84:87]
 v_fmac_f32_dpp v35, v151, v19 row_shr:1 row_mask:0xf bank_mask:0xf bound_ctrl:0
 v_fmac_f32_dpp v32, v156, v16 row_shl:1 row_mask:0xf bank_mask:0xf bound_ctrl:0
 v_mfma_f32_16x16x32_bf16 v[84:87], a[152:155], a[168:171], v[84:87]
 ds_read_b128 a[192:195], v6 offset:20480
 v_fmac_f32_dpp v33, v157, v17 row_shl:1 row_mask:0xf bank_mask:0xf bound_ctrl:0
 v_mfma_f32_16x16x32_bf16 v[84:87], a[156:159], a[172:175], v[84:87]
 ds_read_b128 a[196:199], v7 offset:20480
 v_fmac_f32_dpp v34, v158, v18 row_shl:1 row_mask:0xf bank_mask:0xf bound_ctrl:0
 v_mfma_f32_16x16x32_bf16 v[80:83], a[100:103], a[172:175], v[80:83]
 v_fmac_f32_dpp v35, v159, v19 row_shl:1 row_mask:0xf bank_mask:0xf bound_ctrl:0
 v_fma_f32 v28, v164, v16, v20
 v_mfma_f32_16x16x32_bf16 v[80:83], a[96:99], a[168:171], v[80:83]
 v_exp_f32 v40, v32
 v_mfma_f32_16x16x32_bf16 v[76:79], a[40:43], a[168:171], v[76:79]
 v_exp_f32 v41, v33
 v_mfma_f32_16x16x32_bf16 v[76:79], a[44:47], a[172:175], v[76:79]
 v_exp_f32 v42, v34
 v_mfma_f32_16x16x32_bf16 v[76:79], a[48:51], a[176:179], v[76:79]
 v_exp_f32 v43, v35
 v_mfma_f32_16x16x32_bf16 v[76:79], a[52:55], a[180:183], v[76:79]
 ds_read_b128 a[168:171], v6 offset:24576
 v_fma_f32 v40, v40, s53, s53
 v_mfma_f32_16x16x32_bf16 v[80:83], a[108:111], a[180:183], v[80:83]
 ds_read_b128 a[172:175], v7 offset:24576
 v_fma_f32 v41, v41, s53, s53
 v_mfma_f32_16x16x32_bf16 v[80:83], a[104:107], a[176:179], v[80:83]
 v_fma_f32 v42, v42, s53, s53
 v_fma_f32 v43, v43, s53, s53
 v_mfma_f32_16x16x32_bf16 v[84:87], a[160:163], a[176:179], v[84:87]
 global_load_lds_dwordx4 v241, s[58:59]
 v_mfma_f32_16x16x32_bf16 v[84:87], a[164:167], a[180:183], v[84:87]
 s_waitcnt lgkmcnt(3)
 v_rcp_f32 v40, v40
 v_mfma_f32_16x16x32_bf16 v[88:91], a[0:3], a[184:187], 0
 s_add_u32 m0, s52, 0
 v_rcp_f32 v41, v41
 v_mfma_f32_16x16x32_bf16 v[88:91], a[4:7], a[188:191], v[88:91]
 v_rcp_f32 v42, v42
 v_mfma_f32_16x16x32_bf16 v[92:95], a[60:63], a[188:191], 0
 v_rcp_f32 v43, v43
 v_mfma_f32_16x16x32_bf16 v[92:95], a[56:59], a[184:187], v[92:95]
 ds_read_b128 a[176:179], v6 offset:28672
 v_mul_f32 v40, v40, v32
 v_mfma_f32_16x16x32_bf16 v[96:99], a[112:115], a[184:187], 0
 global_load_lds_dwordx4 v242, s[58:59]
 v_mfma_f32_16x16x32_bf16 v[96:99], a[116:119], a[188:191], v[96:99]
 s_add_u32 m0, s52, 4096
 ds_read_b128 a[180:183], v7 offset:28672
 v_mul_f32 v41, v41, v33
 v_mfma_f32_16x16x32_bf16 v[96:99], a[120:123], a[192:195], v[96:99]
 s_waitcnt lgkmcnt(2)
 ds_read_b128 a[184:187], v6 offset:32768
 v_mul_f32 v42, v42, v34
 v_mfma_f32_16x16x32_bf16 v[96:99], a[124:127], a[196:199], v[96:99]
 ds_read_b128 a[188:191], v7 offset:32768
 v_mul_f32 v43, v43, v35
 v_mfma_f32_16x16x32_bf16 v[92:95], a[68:71], a[196:199], v[92:95]
 v_cvt_pk_bf16_f32 v46, v40, v41
 v_cvt_pk_bf16_f32 v47, v42, v43
 v_mfma_f32_16x16x32_bf16 v[92:95], a[64:67], a[192:195], v[92:95]
 ds_write_b64 v13, v[46:47] offset:14336
 v_mfma_f32_16x16x32_bf16 v[88:91], a[8:11], a[192:195], v[88:91]
 global_load_lds_dwordx4 v243, s[58:59]
 v_mfma_f32_16x16x32_bf16 v[88:91], a[12:15], a[196:199], v[88:91]
 s_add_u32 m0, s52, 8192
 v_fma_f32 v29, v165, v17, v21
 v_fma_f32 v30, v166, v18, v22
 v_mfma_f32_16x16x32_bf16 v[88:91], a[16:19], a[168:171], v[88:91]
 ds_read_b128 a[192:195], v6 offset:36864
 v_fma_f32 v31, v167, v19, v23
 v_mfma_f32_16x16x32_bf16 v[88:91], a[20:23], a[172:175], v[88:91]
 ds_read_b128 a[196:199], v7 offset:36864
 v_fmac_f32_dpp v28, v160, v16 row_shr:1 row_mask:0xf bank_mask:0xf bound_ctrl:0
 v_mfma_f32_16x16x32_bf16 v[92:95], a[76:79], a[172:175], v[92:95]
 v_fmac_f32_dpp v29, v161, v17 row_shr:1 row_mask:0xf bank_mask:0xf bound_ctrl:0
 v_fmac_f32_dpp v30, v162, v18 row_shr:1 row_mask:0xf bank_mask:0xf bound_ctrl:0
 v_mfma_f32_16x16x32_bf16 v[92:95], a[72:75], a[168:171], v[92:95]
 v_fmac_f32_dpp v31, v163, v19 row_shr:1 row_mask:0xf bank_mask:0xf bound_ctrl:0
 v_fmac_f32_dpp v28, v168, v16 row_shl:1 row_mask:0xf bank_mask:0xf bound_ctrl:0
 v_mfma_f32_16x16x32_bf16 v[96:99], a[128:131], a[168:171], v[96:99]
 global_load_lds_dwordx4 v244, s[58:59]
 v_mfma_f32_16x16x32_bf16 v[96:99], a[132:135], a[172:175], v[96:99]
 s_waitcnt lgkmcnt(4)
 v_fmac_f32_dpp v29, v169, v17 row_shl:1 row_mask:0xf bank_mask:0xf bound_ctrl:0
 v_fmac_f32_dpp v30, v170, v18 row_shl:1 row_mask:0xf bank_mask:0xf bound_ctrl:0
 v_mfma_f32_16x16x32_bf16 v[96:99], a[136:139], a[176:179], v[96:99]
 s_add_u32 m0, s52, 12288
 ds_read_b128 a[168:171], v6 offset:40960
 v_fmac_f32_dpp v31, v171, v19 row_shl:1 row_mask:0xf bank_mask:0xf bound_ctrl:0
 v_mfma_f32_16x16x32_bf16 v[96:99], a[140:143], a[180:183], v[96:99]
 v_exp_f32 v36, v28
 v_mfma_f32_16x16x32_bf16 v[92:95], a[84:87], a[180:183], v[92:95]
 v_exp_f32 v37, v29
 v_mfma_f32_16x16x32_bf16 v[92:95], a[80:83], a[176:179], v[92:95]
 v_exp_f32 v38, v30
 v_mfma_f32_16x16x32_bf16 v[88:91], a[24:27], a[176:179], v[88:91]
 global_load_lds_dwordx4 v245, s[58:59]
 v_mfma_f32_16x16x32_bf16 v[88:91], a[28:31], a[180:183], v[88:91]
 s_add_u32 m0, s52, 16384
 v_exp_f32 v39, v31
 v_mfma_f32_16x16x32_bf16 v[88:91], a[32:35], a[184:187], v[88:91]
 s_waitcnt lgkmcnt(1)
 ds_read_b128 a[172:175], v7 offset:40960
 v_fma_f32 v36, v36, s53, s53
 v_mfma_f32_16x16x32_bf16 v[88:91], a[36:39], a[188:191], v[88:91]
 ds_read_b128 a[176:179], v4 offset:55296
 v_fma_f32 v37, v37, s53, s53
 v_mfma_f32_16x16x32_bf16 v[92:95], a[92:95], a[188:191], v[92:95]
 ds_read_b128 a[180:183], v5 offset:55296
 v_fma_f32 v38, v38, s53, s53
 v_mfma_f32_16x16x32_bf16 v[92:95], a[88:91], a[184:187], v[92:95]
 v_fma_f32 v39, v39, s53, s53
 v_fma_f32 v32, v176, v16, v20
 v_mfma_f32_16x16x32_bf16 v[96:99], a[144:147], a[184:187], v[96:99]
 global_load_lds_dwordx4 v246, s[58:59]
 v_mfma_f32_16x16x32_bf16 v[96:99], a[148:151], a[188:191], v[96:99]
 s_add_u32 m0, s52, 20480
 v_rcp_f32 v36, v36
 v_mfma_f32_16x16x32_bf16 v[96:99], a[152:155], a[192:195], v[96:99]
 s_add_u32 s32, s20, 315392
 v_rcp_f32 v37, v37
 v_mfma_f32_16x16x32_bf16 v[96:99], a[156:159], a[196:199], v[96:99]
 s_addc_u32 s33, s21, 0
 v_rcp_f32 v38, v38
 v_mfma_f32_16x16x32_bf16 v[92:95], a[100:103], a[196:199], v[92:95]
 v_rcp_f32 v39, v39
 v_mfma_f32_16x16x32_bf16 v[92:95], a[96:99], a[192:195], v[92:95]
 ds_read_b128 a[184:187], v6 offset:22528
 v_mul_f32 v36, v36, v28
 v_mfma_f32_16x16x32_bf16 v[88:91], a[40:43], a[192:195], v[88:91]
 global_load_lds_dwordx4 v240, s[32:33]
 v_mfma_f32_16x16x32_bf16 v[88:91], a[44:47], a[196:199], v[88:91]
 s_waitcnt lgkmcnt(2)
 ds_read_b128 a[188:191], v7 offset:22528
 v_mul_f32 v37, v37, v29
 v_mfma_f32_16x16x32_bf16 v[88:91], a[48:51], a[168:171], v[88:91]
 buffer_store_dwordx4 v[52:55], v3, s[28:31], s61 offen sc1
 v_mfma_f32_16x16x32_bf16 v[88:91], a[52:55], a[172:175], v[88:91]
 s_add_u32 m0, s52, 24576
 ds_read_b128 a[192:195], v6 offset:26624
 v_mul_f32 v38, v38, v30
 v_mfma_f32_16x16x32_bf16 v[92:95], a[108:111], a[172:175], v[92:95]
 s_add_u32 s58, s20, 286720
 ds_read_b128 a[196:199], v7 offset:26624
 v_mul_f32 v39, v39, v31
 v_mfma_f32_16x16x32_bf16 v[92:95], a[104:107], a[168:171], v[92:95]
 s_addc_u32 s59, s21, 0
 ds_read_b128 v[48:51], v14 offset:8192
 v_cvt_pk_bf16_f32 v44, v36, v37
 v_mfma_f32_16x16x32_bf16 v[96:99], a[160:163], a[168:171], v[96:99]
 s_add_u32 s61, s51, 57344
 v_cvt_pk_bf16_f32 v45, v38, v39
 v_fma_f32 v33, v177, v17, v21
 v_mfma_f32_16x16x32_bf16 v[96:99], a[164:167], a[172:175], v[96:99]
 s_waitcnt lgkmcnt(4)
 ds_write_b64 v13, v[44:45] offset:0
 v_mfma_f32_16x16x32_bf16 v[100:103], a[0:3], a[176:179], 0
 ds_read_b128 a[168:171], v6 offset:30720
 v_fma_f32 v34, v178, v18, v22
 v_mfma_f32_16x16x32_bf16 v[100:103], a[4:7], a[180:183], v[100:103]
 ds_read_b128 a[172:175], v7 offset:30720
 v_fma_f32 v35, v179, v19, v23
 v_mfma_f32_16x16x32_bf16 v[104:107], a[60:63], a[180:183], 0
 v_fmac_f32_dpp v32, v172, v16 row_shr:1 row_mask:0xf bank_mask:0xf bound_ctrl:0
 v_fmac_f32_dpp v33, v173, v17 row_shr:1 row_mask:0xf bank_mask:0xf bound_ctrl:0
 v_mfma_f32_16x16x32_bf16 v[104:107], a[56:59], a[176:179], v[104:107]
 s_waitcnt lgkmcnt(3)
 v_fmac_f32_dpp v34, v174, v18 row_shr:1 row_mask:0xf bank_mask:0xf bound_ctrl:0
 v_fmac_f32_dpp v35, v175, v19 row_shr:1 row_mask:0xf bank_mask:0xf bound_ctrl:0
 v_mfma_f32_16x16x32_bf16 v[108:111], a[112:115], a[176:179], 0
 buffer_store_dwordx4 v[48:51], v3, s[28:31], s61 offen sc1
 v_mfma_f32_16x16x32_bf16 v[108:111], a[116:119], a[180:183], v[108:111]
 v_fmac_f32_dpp v32, v180, v16 row_shl:1 row_mask:0xf bank_mask:0xf bound_ctrl:0
 v_fmac_f32_dpp v33, v181, v17 row_shl:1 row_mask:0xf bank_mask:0xf bound_ctrl:0
 v_mfma_f32_16x16x32_bf16 v[108:111], a[120:123], a[184:187], v[108:111]
 ds_read_b128 a[176:179], v6 offset:34816
 v_fmac_f32_dpp v34, v182, v18 row_shl:1 row_mask:0xf bank_mask:0xf bound_ctrl:0
 v_mfma_f32_16x16x32_bf16 v[108:111], a[124:127], a[188:191], v[108:111]
 ds_read_b128 a[180:183], v7 offset:34816
 v_fmac_f32_dpp v35, v183, v19 row_shl:1 row_mask:0xf bank_mask:0xf bound_ctrl:0
 v_mfma_f32_16x16x32_bf16 v[104:107], a[68:71], a[188:191], v[104:107]
 v_exp_f32 v40, v32
 v_mfma_f32_16x16x32_bf16 v[104:107], a[64:67], a[184:187], v[104:107]
 v_exp_f32 v41, v33
 v_mfma_f32_16x16x32_bf16 v[100:103], a[8:11], a[184:187], v[100:103]
 v_exp_f32 v42, v34
 v_mfma_f32_16x16x32_bf16 v[100:103], a[12:15], a[188:191], v[100:103]
 v_exp_f32 v43, v35
 v_mfma_f32_16x16x32_bf16 v[100:103], a[16:19], a[192:195], v[100:103]
 ds_read_b128 a[184:187], v6 offset:38912
 v_fma_f32 v40, v40, s53, s53
 v_mfma_f32_16x16x32_bf16 v[100:103], a[20:23], a[196:199], v[100:103]
 ds_read_b128 a[188:191], v7 offset:38912
 v_fma_f32 v41, v41, s53, s53
 v_mfma_f32_16x16x32_bf16 v[104:107], a[76:79], a[196:199], v[104:107]
 v_fma_f32 v42, v42, s53, s53
 v_fma_f32 v43, v43, s53, s53
 v_mfma_f32_16x16x32_bf16 v[104:107], a[72:75], a[192:195], v[104:107]
 v_rcp_f32 v40, v40
 v_mfma_f32_16x16x32_bf16 v[108:111], a[128:131], a[192:195], v[108:111]
 v_rcp_f32 v41, v41
 v_mfma_f32_16x16x32_bf16 v[108:111], a[132:135], a[196:199], v[108:111]
 s_waitcnt lgkmcnt(3)
 v_rcp_f32 v42, v42
 v_mfma_f32_16x16x32_bf16 v[108:111], a[136:139], a[168:171], v[108:111]
 v_rcp_f32 v43, v43
 v_mfma_f32_16x16x32_bf16 v[108:111], a[140:143], a[172:175], v[108:111]
 ds_read_b128 a[192:195], v6 offset:43008
 v_mul_f32 v40, v40, v32
 v_mfma_f32_16x16x32_bf16 v[104:107], a[84:87], a[172:175], v[104:107]
 s_waitcnt vmcnt(10)
 ds_read_b128 a[196:199], v7 offset:43008
 v_mul_f32 v41, v41, v33
 v_mfma_f32_16x16x32_bf16 v[104:107], a[80:83], a[168:171], v[104:107]
 s_barrier
 v_mfma_f32_16x16x32_bf16 v[100:103], a[24:27], a[168:171], v[100:103]
 ds_read_b128 v[52:55], v14 offset:12288
 v_mul_f32 v42, v42, v34
 v_mfma_f32_16x16x32_bf16 v[100:103], a[28:31], a[172:175], v[100:103]
 s_add_u32 s61, s51, 86016
 v_mul_f32 v43, v43, v35
 v_cvt_pk_bf16_f32 v46, v40, v41
 v_mfma_f32_16x16x32_bf16 v[100:103], a[32:35], a[176:179], v[100:103]
 s_waitcnt lgkmcnt(3)
 ds_read_b128 a[168:171], v6 offset:16384
 v_cvt_pk_bf16_f32 v47, v42, v43
 v_mfma_f32_16x16x32_bf16 v[100:103], a[36:39], a[180:183], v[100:103]
 ds_write_b64 v13, v[46:47] offset:2048
 v_mfma_f32_16x16x32_bf16 v[104:107], a[92:95], a[180:183], v[104:107]
 ds_read_b128 a[172:175], v7 offset:16384
 v_fma_f32 v28, v188, v16, v20
 v_mfma_f32_16x16x32_bf16 v[104:107], a[88:91], a[176:179], v[104:107]
 v_fma_f32 v29, v189, v17, v21
 v_fma_f32 v30, v190, v18, v22
 v_mfma_f32_16x16x32_bf16 v[108:111], a[144:147], a[176:179], v[108:111]
 s_waitcnt lgkmcnt(3)
 v_fma_f32 v31, v191, v19, v23
 v_fmac_f32_dpp v28, v184, v16 row_shr:1 row_mask:0xf bank_mask:0xf bound_ctrl:0
 v_mfma_f32_16x16x32_bf16 v[108:111], a[148:151], a[180:183], v[108:111]
 v_fmac_f32_dpp v29, v185, v17 row_shr:1 row_mask:0xf bank_mask:0xf bound_ctrl:0
 v_fmac_f32_dpp v30, v186, v18 row_shr:1 row_mask:0xf bank_mask:0xf bound_ctrl:0
 v_mfma_f32_16x16x32_bf16 v[108:111], a[152:155], a[184:187], v[108:111]
 ds_read_b128 a[176:179], v6 offset:49152
 v_fmac_f32_dpp v31, v187, v19 row_shr:1 row_mask:0xf bank_mask:0xf bound_ctrl:0
 v_mfma_f32_16x16x32_bf16 v[108:111], a[156:159], a[188:191], v[108:111]
 ds_read_b128 a[180:183], v7 offset:49152
 v_fmac_f32_dpp v28, v192, v16 row_shl:1 row_mask:0xf bank_mask:0xf bound_ctrl:0
 v_mfma_f32_16x16x32_bf16 v[104:107], a[100:103], a[188:191], v[104:107]
 v_fmac_f32_dpp v29, v193, v17 row_shl:1 row_mask:0xf bank_mask:0xf bound_ctrl:0
 v_fmac_f32_dpp v30, v194, v18 row_shl:1 row_mask:0xf bank_mask:0xf bound_ctrl:0
 v_mfma_f32_16x16x32_bf16 v[104:107], a[96:99], a[184:187], v[104:107]
 v_fmac_f32_dpp v31, v195, v19 row_shl:1 row_mask:0xf bank_mask:0xf bound_ctrl:0
 v_fma_f32 v32, v200, v16, v20
 v_mfma_f32_16x16x32_bf16 v[100:103], a[40:43], a[184:187], v[100:103]
 v_exp_f32 v36, v28
 v_mfma_f32_16x16x32_bf16 v[100:103], a[44:47], a[188:191], v[100:103]
 v_exp_f32 v37, v29
 v_mfma_f32_16x16x32_bf16 v[100:103], a[48:51], a[192:195], v[100:103]
 v_exp_f32 v38, v30
 v_mfma_f32_16x16x32_bf16 v[100:103], a[52:55], a[196:199], v[100:103]
 v_exp_f32 v39, v31
 v_mfma_f32_16x16x32_bf16 v[104:107], a[108:111], a[196:199], v[104:107]
 ds_read_b128 a[184:187], v6 offset:53248
 v_fma_f32 v36, v36, s53, s53
 v_mfma_f32_16x16x32_bf16 v[104:107], a[104:107], a[192:195], v[104:107]
 ds_read_b128 a[188:191], v7 offset:53248
 v_fma_f32 v37, v37, s53, s53
 v_mfma_f32_16x16x32_bf16 v[108:111], a[160:163], a[192:195], v[108:111]
 global_load_lds_dwordx4 v241, s[58:59]
 v_mfma_f32_16x16x32_bf16 v[108:111], a[164:167], a[196:199], v[108:111]
 s_waitcnt lgkmcnt(3)
 v_fma_f32 v38, v38, s53, s53
 v_fma_f32 v39, v39, s53, s53
 v_mfma_f32_16x16x32_bf16 v[112:115], a[0:3], a[168:171], 0
 s_add_u32 m0, s52, 28672
 v_rcp_f32 v36, v36
 v_mfma_f32_16x16x32_bf16 v[112:115], a[4:7], a[172:175], v[112:115]
 v_rcp_f32 v37, v37
 v_mfma_f32_16x16x32_bf16 v[116:119], a[60:63], a[172:175], 0
 v_rcp_f32 v38, v38
 v_mfma_f32_16x16x32_bf16 v[116:119], a[56:59], a[168:171], v[116:119]
 v_rcp_f32 v39, v39
 v_mfma_f32_16x16x32_bf16 v[120:123], a[112:115], a[168:171], 0
 global_load_lds_dwordx4 v242, s[58:59]
 v_mfma_f32_16x16x32_bf16 v[120:123], a[116:119], a[172:175], v[120:123]
 s_add_u32 m0, s52, 32768
 ds_read_b128 a[192:195], v6 offset:57344
 v_mul_f32 v36, v36, v28
 v_mfma_f32_16x16x32_bf16 v[120:123], a[120:123], a[176:179], v[120:123]
 s_waitcnt lgkmcnt(1)
 ds_read_b128 a[196:199], v7 offset:57344
 v_mul_f32 v37, v37, v29
 v_mfma_f32_16x16x32_bf16 v[120:123], a[124:127], a[180:183], v[120:123]
 ds_read_b128 a[168:171], v6 offset:61440
 v_mul_f32 v38, v38, v30
 v_mfma_f32_16x16x32_bf16 v[116:119], a[68:71], a[180:183], v[116:119]
 ds_read_b128 a[172:175], v7 offset:61440
 v_mul_f32 v39, v39, v31
 v_mfma_f32_16x16x32_bf16 v[116:119], a[64:67], a[176:179], v[116:119]
 v_cvt_pk_bf16_f32 v44, v36, v37
 v_cvt_pk_bf16_f32 v45, v38, v39
 v_mfma_f32_16x16x32_bf16 v[112:115], a[8:11], a[176:179], v[112:115]
 global_load_lds_dwordx4 v243, s[58:59]
 v_mfma_f32_16x16x32_bf16 v[112:115], a[12:15], a[180:183], v[112:115]
 s_add_u32 m0, s52, 36864
 ds_write_b64 v13, v[44:45] offset:4096
 v_mfma_f32_16x16x32_bf16 v[112:115], a[16:19], a[184:187], v[112:115]
 ds_read_b128 a[176:179], v8 offset:0
 v_fma_f32 v33, v201, v17, v21
 v_mfma_f32_16x16x32_bf16 v[112:115], a[20:23], a[188:191], v[112:115]
 ds_read_b128 a[180:183], v9 offset:0
 v_fma_f32 v34, v202, v18, v22
 v_mfma_f32_16x16x32_bf16 v[116:119], a[76:79], a[188:191], v[116:119]
 v_fma_f32 v35, v203, v19, v23
 v_fmac_f32_dpp v32, v196, v16 row_shr:1 row_mask:0xf bank_mask:0xf bound_ctrl:0
 v_mfma_f32_16x16x32_bf16 v[116:119], a[72:75], a[184:187], v[116:119]
 v_fmac_f32_dpp v33, v197, v17 row_shr:1 row_mask:0xf bank_mask:0xf bound_ctrl:0
 v_fmac_f32_dpp v34, v198, v18 row_shr:1 row_mask:0xf bank_mask:0xf bound_ctrl:0
 v_mfma_f32_16x16x32_bf16 v[120:123], a[128:131], a[184:187], v[120:123]
 global_load_lds_dwordx4 v244, s[58:59]
 v_mfma_f32_16x16x32_bf16 v[120:123], a[132:135], a[188:191], v[120:123]
 s_waitcnt lgkmcnt(4)
 v_fmac_f32_dpp v35, v199, v19 row_shr:1 row_mask:0xf bank_mask:0xf bound_ctrl:0
 v_fmac_f32_dpp v32, v204, v16 row_shl:1 row_mask:0xf bank_mask:0xf bound_ctrl:0
 v_mfma_f32_16x16x32_bf16 v[120:123], a[136:139], a[192:195], v[120:123]
 s_add_u32 m0, s52, 40960
 ds_read_b128 a[184:187], v8 offset:4096
 v_fmac_f32_dpp v33, v205, v17 row_shl:1 row_mask:0xf bank_mask:0xf bound_ctrl:0
 v_mfma_f32_16x16x32_bf16 v[120:123], a[140:143], a[196:199], v[120:123]
 ds_read_b128 a[188:191], v9 offset:4096
 v_fmac_f32_dpp v34, v206, v18 row_shl:1 row_mask:0xf bank_mask:0xf bound_ctrl:0
 v_mfma_f32_16x16x32_bf16 v[116:119], a[84:87], a[196:199], v[116:119]
 v_fmac_f32_dpp v35, v207, v19 row_shl:1 row_mask:0xf bank_mask:0xf bound_ctrl:0
 v_fma_f32 v28, v68, v16, v20
 v_mfma_f32_16x16x32_bf16 v[116:119], a[80:83], a[192:195], v[116:119]
 v_exp_f32 v40, v32
 v_mfma_f32_16x16x32_bf16 v[112:115], a[24:27], a[192:195], v[112:115]
 global_load_lds_dwordx4 v245, s[58:59]
 v_mfma_f32_16x16x32_bf16 v[112:115], a[28:31], a[196:199], v[112:115]
 s_add_u32 m0, s52, 45056
 v_exp_f32 v41, v33
 v_mfma_f32_16x16x32_bf16 v[112:115], a[32:35], a[168:171], v[112:115]
 s_waitcnt lgkmcnt(2)
 v_exp_f32 v42, v34
 v_mfma_f32_16x16x32_bf16 v[112:115], a[36:39], a[172:175], v[112:115]
 v_exp_f32 v43, v35
 v_mfma_f32_16x16x32_bf16 v[116:119], a[92:95], a[172:175], v[116:119]
 ds_read_b128 a[192:195], v6 offset:18432
 v_fma_f32 v40, v40, s53, s53
 v_mfma_f32_16x16x32_bf16 v[116:119], a[88:91], a[168:171], v[116:119]
 ds_read_b128 a[196:199], v7 offset:18432
 v_fma_f32 v41, v41, s53, s53
 v_mfma_f32_16x16x32_bf16 v[120:123], a[144:147], a[168:171], v[120:123]
 global_load_lds_dwordx4 v246, s[58:59]
 v_mfma_f32_16x16x32_bf16 v[120:123], a[148:151], a[172:175], v[120:123]
 s_add_u32 m0, s52, 49152
 v_fma_f32 v42, v42, s53, s53
 v_fma_f32 v43, v43, s53, s53
 v_mfma_f32_16x16x32_bf16 v[120:123], a[152:155], a[176:179], v[120:123]
 s_add_u32 s32, s20, 344064
 v_rcp_f32 v40, v40
 v_mfma_f32_16x16x32_bf16 v[120:123], a[156:159], a[180:183], v[120:123]
 s_addc_u32 s33, s21, 0
 v_rcp_f32 v41, v41
 v_mfma_f32_16x16x32_bf16 v[116:119], a[100:103], a[180:183], v[116:119]
 v_rcp_f32 v42, v42
 v_mfma_f32_16x16x32_bf16 v[116:119], a[96:99], a[176:179], v[116:119]
 v_rcp_f32 v43, v43
 v_mfma_f32_16x16x32_bf16 v[112:115], a[40:43], a[176:179], v[112:115]
 global_load_lds_dwordx4 v240, s[32:33]
 v_mfma_f32_16x16x32_bf16 v[112:115], a[44:47], a[180:183], v[112:115]
 s_waitcnt lgkmcnt(1)
 ds_read_b128 a[168:171], v6 offset:51200
 v_mul_f32 v40, v40, v32
 v_mfma_f32_16x16x32_bf16 v[112:115], a[48:51], a[184:187], v[112:115]
 buffer_store_dwordx4 v[52:55], v3, s[28:31], s61 offen sc1
 v_mfma_f32_16x16x32_bf16 v[112:115], a[52:55], a[188:191], v[112:115]
 s_add_u32 m0, s52, 57344
 ds_read_b128 a[172:175], v7 offset:51200
 v_mul_f32 v41, v41, v33
 v_mfma_f32_16x16x32_bf16 v[116:119], a[108:111], a[188:191], v[116:119]
 s_add_u32 s58, s20, 315392
 ds_read_b128 a[176:179], v6 offset:55296
 v_mul_f32 v42, v42, v34
 v_mfma_f32_16x16x32_bf16 v[116:119], a[104:107], a[184:187], v[116:119]
L_pad4:
 s_cbranch_execz L_hopdone1
 s_addc_u32 s59, s21, 0
 ds_read_b128 a[180:183], v7 offset:55296
 v_mul_f32 v43, v43, v35
 v_mfma_f32_16x16x32_bf16 v[120:123], a[160:163], a[184:187], v[120:123]
 v_cvt_pk_bf16_f32 v46, v40, v41
 v_cvt_pk_bf16_f32 v47, v42, v43
 v_mfma_f32_16x16x32_bf16 v[120:123], a[164:167], a[188:191], v[120:123]
 ds_write_b64 v13, v[46:47] offset:6144
 v_mfma_f32_16x16x32_bf16 v[124:127], a[0:3], a[192:195], 0
 s_waitcnt lgkmcnt(3)
 ds_read_b128 a[184:187], v6 offset:59392
 v_fma_f32 v29, v69, v17, v21
 v_mfma_f32_16x16x32_bf16 v[124:127], a[4:7], a[196:199], v[124:127]
 ds_read_b128 a[188:191], v7 offset:59392
 v_fma_f32 v30, v70, v18, v22
 v_mfma_f32_16x16x32_bf16 v[128:131], a[60:63], a[196:199], 0
 v_fma_f32 v31, v71, v19, v23
 v_fmac_f32_dpp v28, v64, v16 row_shr:1 row_mask:0xf bank_mask:0xf bound_ctrl:0
 v_mfma_f32_16x16x32_bf16 v[128:131], a[56:59], a[192:195], v[128:131]
 v_fmac_f32_dpp v29, v65, v17 row_shr:1 row_mask:0xf bank_mask:0xf bound_ctrl:0
 v_fmac_f32_dpp v30, v66, v18 row_shr:1 row_mask:0xf bank_mask:0xf bound_ctrl:0
 v_mfma_f32_16x16x32_bf16 v[132:135], a[112:115], a[192:195], 0
 v_fmac_f32_dpp v31, v67, v19 row_shr:1 row_mask:0xf bank_mask:0xf bound_ctrl:0
 v_fmac_f32_dpp v28, v72, v16 row_shl:1 row_mask:0xf bank_mask:0xf bound_ctrl:0
 v_mfma_f32_16x16x32_bf16 v[132:135], a[116:119], a[196:199], v[132:135]
 v_fmac_f32_dpp v29, v73, v17 row_shl:1 row_mask:0xf bank_mask:0xf bound_ctrl:0
 v_fmac_f32_dpp v30, v74, v18 row_shl:1 row_mask:0xf bank_mask:0xf bound_ctrl:0
 v_mfma_f32_16x16x32_bf16 v[132:135], a[120:123], a[168:171], v[132:135]
 ds_read_b128 a[192:195], v6 offset:63488
 v_fmac_f32_dpp v31, v75, v19 row_shl:1 row_mask:0xf bank_mask:0xf bound_ctrl:0
 v_mfma_f32_16x16x32_bf16 v[132:135], a[124:127], a[172:175], v[132:135]
 v_exp_f32 v36, v28
 v_mfma_f32_16x16x32_bf16 v[128:131], a[68:71], a[172:175], v[128:131]
 v_exp_f32 v37, v29
 v_mfma_f32_16x16x32_bf16 v[128:131], a[64:67], a[168:171], v[128:131]
 v_exp_f32 v38, v30
 v_mfma_f32_16x16x32_bf16 v[124:127], a[8:11], a[168:171], v[124:127]
 v_exp_f32 v39, v31
 v_mfma_f32_16x16x32_bf16 v[124:127], a[12:15], a[172:175], v[124:127]
 s_waitcnt lgkmcnt(2)
 ds_read_b128 a[196:199], v7 offset:63488
 v_fma_f32 v36, v36, s53, s53
 v_mfma_f32_16x16x32_bf16 v[124:127], a[16:19], a[176:179], v[124:127]
 ds_read_b128 a[168:171], v8 offset:2048
 v_fma_f32 v37, v37, s53, s53
 v_mfma_f32_16x16x32_bf16 v[124:127], a[20:23], a[180:183], v[124:127]
 ds_read_b128 a[172:175], v9 offset:2048
 v_fma_f32 v38, v38, s53, s53
 v_mfma_f32_16x16x32_bf16 v[128:131], a[76:79], a[180:183], v[128:131]
 v_fma_f32 v39, v39, s53, s53
 v_fma_f32 v32, v80, v16, v20
 v_mfma_f32_16x16x32_bf16 v[128:131], a[72:75], a[176:179], v[128:131]
 v_rcp_f32 v36, v36
 v_mfma_f32_16x16x32_bf16 v[132:135], a[128:131], a[176:179], v[132:135]
 v_rcp_f32 v37, v37
 v_mfma_f32_16x16x32_bf16 v[132:135], a[132:135], a[180:183], v[132:135]
 v_rcp_f32 v38, v38
 v_mfma_f32_16x16x32_bf16 v[132:135], a[136:139], a[184:187], v[132:135]
 s_waitcnt lgkmcnt(2)
 v_rcp_f32 v39, v39
 v_mfma_f32_16x16x32_bf16 v[132:135], a[140:143], a[188:191], v[132:135]
 ds_read_b128 a[176:179], v8 offset:6144
 v_mul_f32 v36, v36, v28
 v_mfma_f32_16x16x32_bf16 v[128:131], a[84:87], a[188:191], v[128:131]
 s_waitcnt vmcnt(11)
 ds_read_b128 a[180:183], v9 offset:6144
 v_mul_f32 v37, v37, v29
 v_mfma_f32_16x16x32_bf16 v[128:131], a[80:83], a[184:187], v[128:131]
 s_barrier
 v_mfma_f32_16x16x32_bf16 v[124:127], a[24:27], a[184:187], v[124:127]
 ds_read_b128 v[48:51], v14 offset:0
 v_mul_f32 v38, v38, v30
 v_mfma_f32_16x16x32_bf16 v[124:127], a[28:31], a[188:191], v[124:127]
 s_add_u32 s61, s51, 114688
 v_mul_f32 v39, v39, v31
 v_cvt_pk_bf16_f32 v44, v36, v37
 v_mfma_f32_16x16x32_bf16 v[124:127], a[32:35], a[192:195], v[124:127]
 ds_read_b128 a[184:187], v6 offset:45056
 v_cvt_pk_bf16_f32 v45, v38, v39
 v_mfma_f32_16x16x32_bf16 v[124:127], a[36:39], a[196:199], v[124:127]
 ds_write_b64 v13, v[44:45] offset:8192
 v_mfma_f32_16x16x32_bf16 v[128:131], a[92:95], a[196:199], v[128:131]
 ds_read_b128 a[188:191], v7 offset:45056
 v_fma_f32 v33, v81, v17, v21
 v_mfma_f32_16x16x32_bf16 v[128:131], a[88:91], a[192:195], v[128:131]
 v_fma_f32 v34, v82, v18, v22
 v_fma_f32 v35, v83, v19, v23
 v_mfma_f32_16x16x32_bf16 v[132:135], a[144:147], a[192:195], v[132:135]
 s_waitcnt lgkmcnt(3)
 v_fmac_f32_dpp v32, v76, v16 row_shr:1 row_mask:0xf bank_mask:0xf bound_ctrl:0
 v_fmac_f32_dpp v33, v77, v17 row_shr:1 row_mask:0xf bank_mask:0xf bound_ctrl:0
 v_mfma_f32_16x16x32_bf16 v[132:135], a[148:151], a[196:199], v[132:135]
 v_fmac_f32_dpp v34, v78, v18 row_shr:1 row_mask:0xf bank_mask:0xf bound_ctrl:0
 v_fmac_f32_dpp v35, v79, v19 row_shr:1 row_mask:0xf bank_mask:0xf bound_ctrl:0
 v_mfma_f32_16x16x32_bf16 v[132:135], a[152:155], a[168:171], v[132:135]
 ds_read_b128 a[192:195], v8 offset:12288
 v_fmac_f32_dpp v32, v84, v16 row_shl:1 row_mask:0xf bank_mask:0xf bound_ctrl:0
 v_mfma_f32_16x16x32_bf16 v[132:135], a[156:159], a[172:175], v[132:135]
 ds_read_b128 a[196:199], v9 offset:12288
 v_fmac_f32_dpp v33, v85, v17 row_shl:1 row_mask:0xf bank_mask:0xf bound_ctrl:0
 v_mfma_f32_16x16x32_bf16 v[128:131], a[100:103], a[172:175], v[128:131]
 v_fmac_f32_dpp v34, v86, v18 row_shl:1 row_mask:0xf bank_mask:0xf bound_ctrl:0
 v_fmac_f32_dpp v35, v87, v19 row_shl:1 row_mask:0xf bank_mask:0xf bound_ctrl:0
 v_mfma_f32_16x16x32_bf16 v[128:131], a[96:99], a[168:171], v[128:131]
 v_exp_f32 v40, v32
 v_mfma_f32_16x16x32_bf16 v[124:127], a[40:43], a[168:171], v[124:127]
 v_exp_f32 v41, v33
 v_mfma_f32_16x16x32_bf16 v[124:127], a[44:47], a[172:175], v[124:127]
 v_exp_f32 v42, v34
 v_mfma_f32_16x16x32_bf16 v[124:127], a[48:51], a[176:179], v[124:127]
 v_exp_f32 v43, v35
 v_mfma_f32_16x16x32_bf16 v[124:127], a[52:55], a[180:183], v[124:127]
 ds_read_b128 a[168:171], v4 offset:0
 v_fma_f32 v40, v40, s53, s53
 v_mfma_f32_16x16x32_bf16 v[128:131], a[108:111], a[180:183], v[128:131]
 ds_read_b128 a[172:175], v5 offset:0
 v_fma_f32 v41, v41, s53, s53
 v_mfma_f32_16x16x32_bf16 v[128:131], a[104:107], a[176:179], v[128:131]
 v_fma_f32 v42, v42, s53, s53
 v_fma_f32 v43, v43, s53, s53
 v_mfma_f32_16x16x32_bf16 v[132:135], a[160:163], a[176:179], v[132:135]
 global_load_lds_dwordx4 v241, s[58:59]
 v_mfma_f32_16x16x32_bf16 v[132:135], a[164:167], a[180:183], v[132:135]
 s_waitcnt lgkmcnt(3)
 v_rcp_f32 v40, v40
 v_mfma_f32_16x16x32_bf16 v[136:139], a[0:3], a[184:187], 0
 s_add_u32 m0, s52, 61440
 v_rcp_f32 v41, v41
 v_mfma_f32_16x16x32_bf16 v[136:139], a[4:7], a[188:191], v[136:139]
 v_rcp_f32 v42, v42
 v_mfma_f32_16x16x32_bf16 v[140:143], a[60:63], a[188:191], 0
 v_rcp_f32 v43, v43
 v_mfma_f32_16x16x32_bf16 v[140:143], a[56:59], a[184:187], v[140:143]
 ds_read_b128 a[176:179], v4 offset:4096
 v_mul_f32 v40, v40, v32
 v_mfma_f32_16x16x32_bf16 v[144:147], a[112:115], a[184:187], 0
 global_load_lds_dwordx4 v242, s[58:59]
 v_mfma_f32_16x16x32_bf16 v[144:147], a[116:119], a[188:191], v[144:147]
 s_add_u32 m0, s52, 65536
 ds_read_b128 a[180:183], v5 offset:4096
 v_mul_f32 v41, v41, v33
 v_mfma_f32_16x16x32_bf16 v[144:147], a[120:123], a[192:195], v[144:147]
 s_waitcnt lgkmcnt(2)
 ds_read_b128 a[184:187], v4 offset:8192
 v_mul_f32 v42, v42, v34
 v_mfma_f32_16x16x32_bf16 v[144:147], a[124:127], a[196:199], v[144:147]
 ds_read_b128 a[188:191], v5 offset:8192
 v_mul_f32 v43, v43, v35
 v_mfma_f32_16x16x32_bf16 v[140:143], a[68:71], a[196:199], v[140:143]
 v_cvt_pk_bf16_f32 v46, v40, v41
 v_cvt_pk_bf16_f32 v47, v42, v43
 v_mfma_f32_16x16x32_bf16 v[140:143], a[64:67], a[192:195], v[140:143]
 ds_write_b64 v13, v[46:47] offset:10240
 v_mfma_f32_16x16x32_bf16 v[136:139], a[8:11], a[192:195], v[136:139]
 global_load_lds_dwordx4 v243, s[58:59]
 v_mfma_f32_16x16x32_bf16 v[136:139], a[12:15], a[196:199], v[136:139]
 s_add_u32 m0, s52, 69632
 v_fma_f32 v28, v92, v16, v20
 v_fma_f32 v29, v93, v17, v21
 v_mfma_f32_16x16x32_bf16 v[136:139], a[16:19], a[168:171], v[136:139]
 ds_read_b128 a[192:195], v4 offset:12288
 v_fma_f32 v30, v94, v18, v22
 v_mfma_f32_16x16x32_bf16 v[136:139], a[20:23], a[172:175], v[136:139]
 ds_read_b128 a[196:199], v5 offset:12288
 v_fma_f32 v31, v95, v19, v23
 v_mfma_f32_16x16x32_bf16 v[140:143], a[76:79], a[172:175], v[140:143]
 v_fmac_f32_dpp v28, v88, v16 row_shr:1 row_mask:0xf bank_mask:0xf bound_ctrl:0
 v_fmac_f32_dpp v29, v89, v17 row_shr:1 row_mask:0xf bank_mask:0xf bound_ctrl:0
 v_mfma_f32_16x16x32_bf16 v[140:143], a[72:75], a[168:171], v[140:143]
 v_fmac_f32_dpp v30, v90, v18 row_shr:1 row_mask:0xf bank_mask:0xf bound_ctrl:0
 v_fmac_f32_dpp v31, v91, v19 row_shr:1 row_mask:0xf bank_mask:0xf bound_ctrl:0
 v_mfma_f32_16x16x32_bf16 v[144:147], a[128:131], a[168:171], v[144:147]
 global_load_lds_dwordx4 v244, s[58:59]
 v_mfma_f32_16x16x32_bf16 v[144:147], a[132:135], a[172:175], v[144:147]
 s_waitcnt lgkmcnt(4)
 v_fmac_f32_dpp v28, v96, v16 row_shl:1 row_mask:0xf bank_mask:0xf bound_ctrl:0
 v_fmac_f32_dpp v29, v97, v17 row_shl:1 row_mask:0xf bank_mask:0xf bound_ctrl:0
 v_mfma_f32_16x16x32_bf16 v[144:147], a[136:139], a[176:179], v[144:147]
 s_add_u32 m0, s52, 53248
 ds_read_b128 a[168:171], v4 offset:16384
 v_fmac_f32_dpp v30, v98, v18 row_shl:1 row_mask:0xf bank_mask:0xf bound_ctrl:0
 v_mfma_f32_16x16x32_bf16 v[144:147], a[140:143], a[180:183], v[144:147]
 ds_read_b128 a[172:175], v5 offset:16384
 v_fmac_f32_dpp v31, v99, v19 row_shl:1 row_mask:0xf bank_mask:0xf bound_ctrl:0
 v_mfma_f32_16x16x32_bf16 v[140:143], a[84:87], a[180:183], v[140:143]
 v_exp_f32 v36, v28
 v_mfma_f32_16x16x32_bf16 v[140:143], a[80:83], a[176:179], v[140:143]
 v_exp_f32 v37, v29
 v_mfma_f32_16x16x32_bf16 v[136:139], a[24:27], a[176:179], v[136:139]
 global_load_lds_dwordx4 v245, s[58:59]
 v_mfma_f32_16x16x32_bf16 v[136:139], a[28:31], a[180:183], v[136:139]
 s_waitcnt lgkmcnt(3)
 v_exp_f32 v38, v30
 v_mfma_f32_16x16x32_bf16 v[136:139], a[32:35], a[184:187], v[136:139]
 s_add_u32 m0, s52, 77824
 v_exp_f32 v39, v31
 v_mfma_f32_16x16x32_bf16 v[136:139], a[36:39], a[188:191], v[136:139]
 ds_read_b128 a[176:179], v6 offset:47104
 v_fma_f32 v36, v36, s53, s53
 v_mfma_f32_16x16x32_bf16 v[140:143], a[92:95], a[188:191], v[140:143]
 ds_read_b128 a[180:183], v7 offset:47104
 v_fma_f32 v37, v37, s53, s53
 v_mfma_f32_16x16x32_bf16 v[140:143], a[88:91], a[184:187], v[140:143]
 v_fma_f32 v38, v38, s53, s53
 v_fma_f32 v39, v39, s53, s53
 v_mfma_f32_16x16x32_bf16 v[144:147], a[144:147], a[184:187], v[144:147]
 global_load_lds_dwordx4 v246, s[58:59]
 v_mfma_f32_16x16x32_bf16 v[144:147], a[148:151], a[188:191], v[144:147]
 s_add_u32 m0, s52, 73728
 v_rcp_f32 v36, v36
 v_mfma_f32_16x16x32_bf16 v[144:147], a[152:155], a[192:195], v[144:147]
 s_waitcnt lgkmcnt(2)
 v_rcp_f32 v37, v37
 v_mfma_f32_16x16x32_bf16 v[144:147], a[156:159], a[196:199], v[144:147]
 s_add_u32 s32, s20, 372736
 v_rcp_f32 v38, v38
 v_mfma_f32_16x16x32_bf16 v[140:143], a[100:103], a[196:199], v[140:143]
 s_addc_u32 s33, s21, 0
 v_rcp_f32 v39, v39
 v_mfma_f32_16x16x32_bf16 v[140:143], a[96:99], a[192:195], v[140:143]
 ds_read_b128 a[184:187], v8 offset:14336
 v_mul_f32 v36, v36, v28
 v_mfma_f32_16x16x32_bf16 v[136:139], a[40:43], a[192:195], v[136:139]
 global_load_lds_dwordx4 v240, s[32:33]
 v_mfma_f32_16x16x32_bf16 v[136:139], a[44:47], a[196:199], v[136:139]
 buffer_store_dwordx4 v[48:51], v3, s[28:31], s61 offen sc1
 v_mfma_f32_16x16x32_bf16 v[136:139], a[48:51], a[168:171], v[136:139]
 s_add_u32 m0, s52, 86016
 ds_read_b128 a[188:191], v9 offset:14336
 v_mul_f32 v37, v37, v29
 v_mfma_f32_16x16x32_bf16 v[136:139], a[52:55], a[172:175], v[136:139]
 s_add_u32 s58, s20, 344064
 ds_read_b128 a[192:195], v4 offset:2048
 v_mul_f32 v38, v38, v30
 v_mfma_f32_16x16x32_bf16 v[140:143], a[108:111], a[172:175], v[140:143]
 s_addc_u32 s59, s21, 0
 ds_read_b128 a[196:199], v5 offset:2048
 v_mul_f32 v39, v39, v31
 v_mfma_f32_16x16x32_bf16 v[140:143], a[104:107], a[168:171], v[140:143]
 ds_read_b128 v[52:55], v14 offset:4096
 v_cvt_pk_bf16_f32 v44, v36, v37
 v_mfma_f32_16x16x32_bf16 v[144:147], a[160:163], a[168:171], v[144:147]
 s_add_u32 s61, s51, 143360
 v_cvt_pk_bf16_f32 v45, v38, v39
 v_fma_f32 v32, v104, v16, v20
 v_mfma_f32_16x16x32_bf16 v[144:147], a[164:167], a[172:175], v[144:147]
 s_waitcnt lgkmcnt(4)
 ds_write_b64 v13, v[44:45] offset:12288
 v_mfma_f32_16x16x32_bf16 v[148:151], a[0:3], a[176:179], 0
 ds_read_b128 a[168:171], v4 offset:6144
 v_fma_f32 v33, v105, v17, v21
 v_mfma_f32_16x16x32_bf16 v[148:151], a[4:7], a[180:183], v[148:151]
 ds_read_b128 a[172:175], v5 offset:6144
 v_fma_f32 v34, v106, v18, v22
 v_mfma_f32_16x16x32_bf16 v[152:155], a[60:63], a[180:183], 0
 v_fma_f32 v35, v107, v19, v23
 v_fmac_f32_dpp v32, v100, v16 row_shr:1 row_mask:0xf bank_mask:0xf bound_ctrl:0
 v_mfma_f32_16x16x32_bf16 v[152:155], a[56:59], a[176:179], v[152:155]
 s_waitcnt lgkmcnt(3)
 v_fmac_f32_dpp v33, v101, v17 row_shr:1 row_mask:0xf bank_mask:0xf bound_ctrl:0
 v_fmac_f32_dpp v34, v102, v18 row_shr:1 row_mask:0xf bank_mask:0xf bound_ctrl:0
 v_mfma_f32_16x16x32_bf16 v[156:159], a[112:115], a[176:179], 0
 buffer_store_dwordx4 v[52:55], v3, s[28:31], s61 offen sc1
 v_mfma_f32_16x16x32_bf16 v[156:159], a[116:119], a[180:183], v[156:159]
 v_fmac_f32_dpp v35, v103, v19 row_shr:1 row_mask:0xf bank_mask:0xf bound_ctrl:0
 v_fmac_f32_dpp v32, v108, v16 row_shl:1 row_mask:0xf bank_mask:0xf bound_ctrl:0
 v_mfma_f32_16x16x32_bf16 v[156:159], a[120:123], a[184:187], v[156:159]
 ds_read_b128 a[176:179], v4 offset:10240
 v_fmac_f32_dpp v33, v109, v17 row_shl:1 row_mask:0xf bank_mask:0xf bound_ctrl:0
 v_mfma_f32_16x16x32_bf16 v[156:159], a[124:127], a[188:191], v[156:159]
 ds_read_b128 a[180:183], v5 offset:10240
 v_fmac_f32_dpp v34, v110, v18 row_shl:1 row_mask:0xf bank_mask:0xf bound_ctrl:0
 v_mfma_f32_16x16x32_bf16 v[152:155], a[68:71], a[188:191], v[152:155]
 v_fmac_f32_dpp v35, v111, v19 row_shl:1 row_mask:0xf bank_mask:0xf bound_ctrl:0
 v_mfma_f32_16x16x32_bf16 v[152:155], a[64:67], a[184:187], v[152:155]
 v_exp_f32 v40, v32
 v_mfma_f32_16x16x32_bf16 v[148:151], a[8:11], a[184:187], v[148:151]
 v_exp_f32 v41, v33
 v_mfma_f32_16x16x32_bf16 v[148:151], a[12:15], a[188:191], v[148:151]
 v_exp_f32 v42, v34
 v_mfma_f32_16x16x32_bf16 v[148:151], a[16:19], a[192:195], v[148:151]
 v_exp_f32 v43, v35
 v_mfma_f32_16x16x32_bf16 v[148:151], a[20:23], a[196:199], v[148:151]
 ds_read_b128 a[184:187], v4 offset:14336
 v_fma_f32 v40, v40, s53, s53
 v_mfma_f32_16x16x32_bf16 v[152:155], a[76:79], a[196:199], v[152:155]
 ds_read_b128 a[188:191], v5 offset:14336
 v_fma_f32 v41, v41, s53, s53
 v_mfma_f32_16x16x32_bf16 v[152:155], a[72:75], a[192:195], v[152:155]
 v_fma_f32 v42, v42, s53, s53
 v_fma_f32 v43, v43, s53, s53
 v_mfma_f32_16x16x32_bf16 v[156:159], a[128:131], a[192:195], v[156:159]
 v_rcp_f32 v40, v40
 v_mfma_f32_16x16x32_bf16 v[156:159], a[132:135], a[196:199], v[156:159]
 s_waitcnt lgkmcnt(3)
 v_rcp_f32 v41, v41
 v_mfma_f32_16x16x32_bf16 v[156:159], a[136:139], a[168:171], v[156:159]
 v_rcp_f32 v42, v42
 v_mfma_f32_16x16x32_bf16 v[156:159], a[140:143], a[172:175], v[156:159]
 v_rcp_f32 v43, v43
 v_mfma_f32_16x16x32_bf16 v[152:155], a[84:87], a[172:175], v[152:155]
 s_waitcnt vmcnt(11)
 ds_read_b128 a[192:195], v4 offset:18432
 v_mul_f32 v40, v40, v32
 v_mfma_f32_16x16x32_bf16 v[152:155], a[80:83], a[168:171], v[152:155]
 s_barrier
 v_mfma_f32_16x16x32_bf16 v[148:151], a[24:27], a[168:171], v[148:151]
 ds_read_b128 a[196:199], v5 offset:18432
 v_mul_f32 v41, v41, v33
 v_mfma_f32_16x16x32_bf16 v[148:151], a[28:31], a[172:175], v[148:151]
 ds_read_b128 v[48:51], v14 offset:8192
 v_mul_f32 v42, v42, v34
 v_mfma_f32_16x16x32_bf16 v[148:151], a[32:35], a[176:179], v[148:151]
 s_waitcnt lgkmcnt(3)
 ds_read_b128 a[168:171], v8 offset:8192
 v_mul_f32 v43, v43, v35
 v_mfma_f32_16x16x32_bf16 v[148:151], a[36:39], a[180:183], v[148:151]
 s_add_u32 s61, s51, 172032
 ds_read_b128 a[172:175], v9 offset:8192
 v_cvt_pk_bf16_f32 v46, v40, v41
 v_mfma_f32_16x16x32_bf16 v[152:155], a[92:95], a[180:183], v[152:155]
 v_cvt_pk_bf16_f32 v47, v42, v43
 v_fma_f32 v28, v116, v16, v20
 v_mfma_f32_16x16x32_bf16 v[152:155], a[88:91], a[176:179], v[152:155]
 ds_write_b64 v13, v[46:47] offset:14336
 v_mfma_f32_16x16x32_bf16 v[156:159], a[144:147], a[176:179], v[156:159]
 v_fma_f32 v29, v117, v17, v21
 v_fma_f32 v30, v118, v18, v22
 v_mfma_f32_16x16x32_bf16 v[156:159], a[148:151], a[180:183], v[156:159]
 s_waitcnt lgkmcnt(3)
 v_fma_f32 v31, v119, v19, v23
 v_fmac_f32_dpp v28, v112, v16 row_shr:1 row_mask:0xf bank_mask:0xf bound_ctrl:0
 v_mfma_f32_16x16x32_bf16 v[156:159], a[152:155], a[184:187], v[156:159]
 ds_read_b128 a[176:179], v4 offset:24576
 v_fmac_f32_dpp v29, v113, v17 row_shr:1 row_mask:0xf bank_mask:0xf bound_ctrl:0
 v_mfma_f32_16x16x32_bf16 v[156:159], a[156:159], a[188:191], v[156:159]
 ds_read_b128 a[180:183], v5 offset:24576
 v_fmac_f32_dpp v30, v114, v18 row_shr:1 row_mask:0xf bank_mask:0xf bound_ctrl:0
 v_mfma_f32_16x16x32_bf16 v[152:155], a[100:103], a[188:191], v[152:155]
 v_fmac_f32_dpp v31, v115, v19 row_shr:1 row_mask:0xf bank_mask:0xf bound_ctrl:0
 v_fmac_f32_dpp v28, v120, v16 row_shl:1 row_mask:0xf bank_mask:0xf bound_ctrl:0
 v_mfma_f32_16x16x32_bf16 v[152:155], a[96:99], a[184:187], v[152:155]
 v_fmac_f32_dpp v29, v121, v17 row_shl:1 row_mask:0xf bank_mask:0xf bound_ctrl:0
 v_fmac_f32_dpp v30, v122, v18 row_shl:1 row_mask:0xf bank_mask:0xf bound_ctrl:0
 v_mfma_f32_16x16x32_bf16 v[148:151], a[40:43], a[184:187], v[148:151]
 v_fmac_f32_dpp v31, v123, v19 row_shl:1 row_mask:0xf bank_mask:0xf bound_ctrl:0
 v_fma_f32 v32, v128, v16, v20
 v_mfma_f32_16x16x32_bf16 v[148:151], a[44:47], a[188:191], v[148:151]
 v_exp_f32 v36, v28
 v_mfma_f32_16x16x32_bf16 v[148:151], a[48:51], a[192:195], v[148:151]
 v_exp_f32 v37, v29
 v_mfma_f32_16x16x32_bf16 v[148:151], a[52:55], a[196:199], v[148:151]
 v_exp_f32 v38, v30
 v_mfma_f32_16x16x32_bf16 v[152:155], a[108:111], a[196:199], v[152:155]
 v_exp_f32 v39, v31
 v_mfma_f32_16x16x32_bf16 v[152:155], a[104:107], a[192:195], v[152:155]
 ds_read_b128 a[184:187], v4 offset:28672
 v_fma_f32 v36, v36, s53, s53
 v_mfma_f32_16x16x32_bf16 v[156:159], a[160:163], a[192:195], v[156:159]
 global_load_lds_dwordx4 v241, s[58:59]
 v_mfma_f32_16x16x32_bf16 v[156:159], a[164:167], a[196:199], v[156:159]
 s_waitcnt lgkmcnt(2)
 ds_read_b128 a[188:191], v5 offset:28672
 v_fma_f32 v37, v37, s53, s53
 v_mfma_f32_16x16x32_bf16 v[160:163], a[0:3], a[168:171], 0
 s_add_u32 m0, s52, 90112
 ds_read_b128 a[192:195], v4 offset:32768
 v_fma_f32 v38, v38, s53, s53
 v_mfma_f32_16x16x32_bf16 v[160:163], a[4:7], a[172:175], v[160:163]
 ds_read_b128 a[196:199], v5 offset:32768
 v_fma_f32 v39, v39, s53, s53
 v_mfma_f32_16x16x32_bf16 v[164:167], a[60:63], a[172:175], 0
 v_rcp_f32 v36, v36
 v_mfma_f32_16x16x32_bf16 v[164:167], a[56:59], a[168:171], v[164:167]
 v_rcp_f32 v37, v37
 v_mfma_f32_16x16x32_bf16 v[168:171], a[112:115], a[168:171], 0
 global_load_lds_dwordx4 v242, s[58:59]
 v_mfma_f32_16x16x32_bf16 v[168:171], a[116:119], a[172:175], v[168:171]
 s_add_u32 m0, s52, 94208
 v_rcp_f32 v38, v38
 v_mfma_f32_16x16x32_bf16 v[168:171], a[120:123], a[176:179], v[168:171]
 s_waitcnt lgkmcnt(2)
 v_rcp_f32 v39, v39
 v_mfma_f32_16x16x32_bf16 v[168:171], a[124:127], a[180:183], v[168:171]
 ds_read_b128 a[168:171], v4 offset:36864
 v_mul_f32 v36, v36, v28
 v_mfma_f32_16x16x32_bf16 v[164:167], a[68:71], a[180:183], v[164:167]
 ds_read_b128 a[172:175], v5 offset:36864
 v_mul_f32 v37, v37, v29
 v_mfma_f32_16x16x32_bf16 v[164:167], a[64:67], a[176:179], v[164:167]
 v_mul_f32 v38, v38, v30
 v_mul_f32 v39, v39, v31
 v_mfma_f32_16x16x32_bf16 v[160:163], a[8:11], a[176:179], v[160:163]
 global_load_lds_dwordx4 v243, s[58:59]
 v_mfma_f32_16x16x32_bf16 v[160:163], a[12:15], a[180:183], v[160:163]
 s_add_u32 m0, s52, 81920
 v_cvt_pk_bf16_f32 v44, v36, v37
 v_cvt_pk_bf16_f32 v45, v38, v39
 v_mfma_f32_16x16x32_bf16 v[160:163], a[16:19], a[184:187], v[160:163]
 ds_write_b64 v13, v[44:45] offset:0
 v_mfma_f32_16x16x32_bf16 v[160:163], a[20:23], a[188:191], v[160:163]
 ds_read_b128 a[176:179], v4 offset:40960
 v_fma_f32 v33, v129, v17, v21
 v_mfma_f32_16x16x32_bf16 v[164:167], a[76:79], a[188:191], v[164:167]
 ds_read_b128 a[180:183], v5 offset:40960
 v_fma_f32 v34, v130, v18, v22
 v_mfma_f32_16x16x32_bf16 v[164:167], a[72:75], a[184:187], v[164:167]
 v_fma_f32 v35, v131, v19, v23
 v_fmac_f32_dpp v32, v124, v16 row_shr:1 row_mask:0xf bank_mask:0xf bound_ctrl:0
 v_mfma_f32_16x16x32_bf16 v[168:171], a[128:131], a[184:187], v[168:171]
 global_load_lds_dwordx4 v244, s[58:59]
 v_mfma_f32_16x16x32_bf16 v[168:171], a[132:135], a[188:191], v[168:171]
 s_waitcnt lgkmcnt(4)
 v_fmac_f32_dpp v33, v125, v17 row_shr:1 row_mask:0xf bank_mask:0xf bound_ctrl:0
 v_fmac_f32_dpp v34, v126, v18 row_shr:1 row_mask:0xf bank_mask:0xf bound_ctrl:0
 v_mfma_f32_16x16x32_bf16 v[168:171], a[136:139], a[192:195], v[168:171]
 s_add_u32 m0, s52, 98304
 ds_read_b128 a[184:187], v4 offset:45056
 v_fmac_f32_dpp v35, v127, v19 row_shr:1 row_mask:0xf bank_mask:0xf bound_ctrl:0
 v_mfma_f32_16x16x32_bf16 v[168:171], a[140:143], a[196:199], v[168:171]
 ds_read_b128 a[188:191], v5 offset:45056
 v_fmac_f32_dpp v32, v132, v16 row_shl:1 row_mask:0xf bank_mask:0xf bound_ctrl:0
 v_mfma_f32_16x16x32_bf16 v[164:167], a[84:87], a[196:199], v[164:167]
 v_fmac_f32_dpp v33, v133, v17 row_shl:1 row_mask:0xf bank_mask:0xf bound_ctrl:0
 v_fmac_f32_dpp v34, v134, v18 row_shl:1 row_mask:0xf bank_mask:0xf bound_ctrl:0
 v_mfma_f32_16x16x32_bf16 v[164:167], a[80:83], a[192:195], v[164:167]
 v_fmac_f32_dpp v35, v135, v19 row_shl:1 row_mask:0xf bank_mask:0xf bound_ctrl:0
 v_fma_f32 v28, v140, v16, v20
 v_mfma_f32_16x16x32_bf16 v[160:163], a[24:27], a[192:195], v[160:163]
 global_load_lds_dwordx4 v245, s[58:59]
 v_mfma_f32_16x16x32_bf16 v[160:163], a[28:31], a[196:199], v[160:163]
 s_add_u32 m0, s52, 102400
 v_exp_f32 v40, v32
 v_mfma_f32_16x16x32_bf16 v[160:163], a[32:35], a[168:171], v[160:163]
 s_waitcnt lgkmcnt(2)
 v_exp_f32 v41, v33
 v_mfma_f32_16x16x32_bf16 v[160:163], a[36:39], a[172:175], v[160:163]
 v_exp_f32 v42, v34
 v_mfma_f32_16x16x32_bf16 v[164:167], a[92:95], a[172:175], v[164:167]
 v_exp_f32 v43, v35
 v_mfma_f32_16x16x32_bf16 v[164:167], a[88:91], a[168:171], v[164:167]
 ds_read_b128 a[192:195], v8 offset:10240
 v_fma_f32 v40, v40, s53, s53
 v_mfma_f32_16x16x32_bf16 v[168:171], a[144:147], a[168:171], v[168:171]
 global_load_lds_dwordx4 v246, s[58:59]
 v_mfma_f32_16x16x32_bf16 v[168:171], a[148:151], a[172:175], v[168:171]
 s_add_u32 m0, s52, 106496
 ds_read_b128 a[196:199], v9 offset:10240
 v_fma_f32 v41, v41, s53, s53
 v_mfma_f32_16x16x32_bf16 v[168:171], a[152:155], a[176:179], v[168:171]
 s_add_u32 s58, s20, 372736
 ds_read_b128 a[168:171], v4 offset:26624
 v_fma_f32 v42, v42, s53, s53
 v_mfma_f32_16x16x32_bf16 v[168:171], a[156:159], a[180:183], v[168:171]
 s_addc_u32 s59, s21, 0
 ds_read_b128 a[172:175], v5 offset:26624
 v_fma_f32 v43, v43, s53, s53
 v_mfma_f32_16x16x32_bf16 v[164:167], a[100:103], a[180:183], v[164:167]
 v_rcp_f32 v40, v40
 v_mfma_f32_16x16x32_bf16 v[164:167], a[96:99], a[176:179], v[164:167]
 v_rcp_f32 v41, v41
 v_mfma_f32_16x16x32_bf16 v[160:163], a[40:43], a[176:179], v[160:163]
 v_rcp_f32 v42, v42
 v_mfma_f32_16x16x32_bf16 v[160:163], a[44:47], a[180:183], v[160:163]
 s_waitcnt lgkmcnt(3)
 v_rcp_f32 v43, v43
 v_mfma_f32_16x16x32_bf16 v[160:163], a[48:51], a[184:187], v[160:163]
 buffer_store_dwordx4 v[48:51], v3, s[28:31], s61 offen sc1
 v_mfma_f32_16x16x32_bf16 v[160:163], a[52:55], a[188:191], v[160:163]
 ds_read_b128 a[176:179], v4 offset:30720
 v_mul_f32 v40, v40, v32
 v_mfma_f32_16x16x32_bf16 v[164:167], a[108:111], a[188:191], v[164:167]
 ds_read_b128 a[180:183], v5 offset:30720
 v_mul_f32 v41, v41, v33
 v_mfma_f32_16x16x32_bf16 v[164:167], a[104:107], a[184:187], v[164:167]
 v_mul_f32 v42, v42, v34
 v_mul_f32 v43, v43, v35
 v_mfma_f32_16x16x32_bf16 v[168:171], a[160:163], a[184:187], v[168:171]
 v_cvt_pk_bf16_f32 v46, v40, v41
 v_cvt_pk_bf16_f32 v47, v42, v43
 v_mfma_f32_16x16x32_bf16 v[168:171], a[164:167], a[188:191], v[168:171]
 ds_write_b64 v13, v[46:47] offset:2048
 v_mfma_f32_16x16x32_bf16 v[172:175], a[0:3], a[192:195], 0
 s_waitcnt lgkmcnt(3)
 ds_read_b128 a[184:187], v4 offset:34816
 v_fma_f32 v29, v141, v17, v21
 v_mfma_f32_16x16x32_bf16 v[172:175], a[4:7], a[196:199], v[172:175]
 ds_read_b128 a[188:191], v5 offset:34816
 v_fma_f32 v30, v142, v18, v22
 v_mfma_f32_16x16x32_bf16 v[176:179], a[60:63], a[196:199], 0
 v_fma_f32 v31, v143, v19, v23
 v_fmac_f32_dpp v28, v136, v16 row_shr:1 row_mask:0xf bank_mask:0xf bound_ctrl:0
 v_mfma_f32_16x16x32_bf16 v[176:179], a[56:59], a[192:195], v[176:179]
 v_fmac_f32_dpp v29, v137, v17 row_shr:1 row_mask:0xf bank_mask:0xf bound_ctrl:0
 v_fmac_f32_dpp v30, v138, v18 row_shr:1 row_mask:0xf bank_mask:0xf bound_ctrl:0
 v_mfma_f32_16x16x32_bf16 v[180:183], a[112:115], a[192:195], 0
 v_fmac_f32_dpp v31, v139, v19 row_shr:1 row_mask:0xf bank_mask:0xf bound_ctrl:0
 v_fmac_f32_dpp v28, v144, v16 row_shl:1 row_mask:0xf bank_mask:0xf bound_ctrl:0
 v_mfma_f32_16x16x32_bf16 v[180:183], a[116:119], a[196:199], v[180:183]
 v_fmac_f32_dpp v29, v145, v17 row_shl:1 row_mask:0xf bank_mask:0xf bound_ctrl:0
 v_fmac_f32_dpp v30, v146, v18 row_shl:1 row_mask:0xf bank_mask:0xf bound_ctrl:0
 v_mfma_f32_16x16x32_bf16 v[180:183], a[120:123], a[168:171], v[180:183]
 ds_read_b128 a[192:195], v4 offset:38912
 v_fmac_f32_dpp v31, v147, v19 row_shl:1 row_mask:0xf bank_mask:0xf bound_ctrl:0
 v_mfma_f32_16x16x32_bf16 v[180:183], a[124:127], a[172:175], v[180:183]
 v_exp_f32 v36, v28
 v_mfma_f32_16x16x32_bf16 v[176:179], a[68:71], a[172:175], v[176:179]
 v_exp_f32 v37, v29
 v_mfma_f32_16x16x32_bf16 v[176:179], a[64:67], a[168:171], v[176:179]
 v_exp_f32 v38, v30
 v_mfma_f32_16x16x32_bf16 v[172:175], a[8:11], a[168:171], v[172:175]
 v_exp_f32 v39, v31
 v_mfma_f32_16x16x32_bf16 v[172:175], a[12:15], a[172:175], v[172:175]
 s_waitcnt lgkmcnt(2)
 ds_read_b128 a[196:199], v5 offset:38912
 v_fma_f32 v36, v36, s53, s53
 v_mfma_f32_16x16x32_bf16 v[172:175], a[16:19], a[176:179], v[172:175]
 ds_read_b128 a[168:171], v4 offset:43008
 v_fma_f32 v37, v37, s53, s53
 v_mfma_f32_16x16x32_bf16 v[172:175], a[20:23], a[180:183], v[172:175]
 ds_read_b128 a[172:175], v5 offset:43008
 v_fma_f32 v38, v38, s53, s53
 v_mfma_f32_16x16x32_bf16 v[176:179], a[76:79], a[180:183], v[176:179]
 v_fma_f32 v39, v39, s53, s53
 v_fma_f32 v32, v152, v16, v20
 v_mfma_f32_16x16x32_bf16 v[176:179], a[72:75], a[176:179], v[176:179]
 v_rcp_f32 v36, v36
 v_mfma_f32_16x16x32_bf16 v[180:183], a[128:131], a[176:179], v[180:183]
 v_rcp_f32 v37, v37
 v_mfma_f32_16x16x32_bf16 v[180:183], a[132:135], a[180:183], v[180:183]
 s_waitcnt lgkmcnt(3)
 v_rcp_f32 v38, v38
 v_mfma_f32_16x16x32_bf16 v[180:183], a[136:139], a[184:187], v[180:183]
 v_rcp_f32 v39, v39
 v_mfma_f32_16x16x32_bf16 v[180:183], a[140:143], a[188:191], v[180:183]
 ds_read_b128 a[176:179], v4 offset:47104
 v_mul_f32 v36, v36, v28
 v_mfma_f32_16x16x32_bf16 v[176:179], a[84:87], a[188:191], v[176:179]
 s_waitcnt vmcnt(10)
 ds_read_b128 a[180:183], v5 offset:47104
 v_mul_f32 v37, v37, v29
 v_mfma_f32_16x16x32_bf16 v[176:179], a[80:83], a[184:187], v[176:179]
 s_barrier
 v_mfma_f32_16x16x32_bf16 v[172:175], a[24:27], a[184:187], v[172:175]
 ds_read_b128 v[52:55], v14 offset:12288
 v_mul_f32 v38, v38, v30
 v_mfma_f32_16x16x32_bf16 v[172:175], a[28:31], a[188:191], v[172:175]
 s_add_u32 s61, s51, 200704
 v_mul_f32 v39, v39, v31
 v_cvt_pk_bf16_f32 v44, v36, v37
 v_mfma_f32_16x16x32_bf16 v[172:175], a[32:35], a[192:195], v[172:175]
 s_waitcnt lgkmcnt(3)
 ds_read_b128 a[184:187], v4 offset:20480
 v_cvt_pk_bf16_f32 v45, v38, v39
 v_mfma_f32_16x16x32_bf16 v[172:175], a[36:39], a[196:199], v[172:175]
 ds_write_b64 v13, v[44:45] offset:4096
 v_mfma_f32_16x16x32_bf16 v[176:179], a[92:95], a[196:199], v[176:179]
 ds_read_b128 a[188:191], v5 offset:20480
 v_fma_f32 v33, v153, v17, v21
 v_mfma_f32_16x16x32_bf16 v[176:179], a[88:91], a[192:195], v[176:179]
 v_fma_f32 v34, v154, v18, v22
 v_fma_f32 v35, v155, v19, v23
 v_mfma_f32_16x16x32_bf16 v[180:183], a[144:147], a[192:195], v[180:183]
 s_waitcnt lgkmcnt(3)
 v_fmac_f32_dpp v32, v148, v16 row_shr:1 row_mask:0xf bank_mask:0xf bound_ctrl:0
 v_fmac_f32_dpp v33, v149, v17 row_shr:1 row_mask:0xf bank_mask:0xf bound_ctrl:0
 v_mfma_f32_16x16x32_bf16 v[180:183], a[148:151], a[196:199], v[180:183]
L_pad5:
 s_cbranch_execz L_hopdone1
 v_fmac_f32_dpp v34, v150, v18 row_shr:1 row_mask:0xf bank_mask:0xf bound_ctrl:0
 v_fmac_f32_dpp v35, v151, v19 row_shr:1 row_mask:0xf bank_mask:0xf bound_ctrl:0
 v_mfma_f32_16x16x32_bf16 v[180:183], a[152:155], a[168:171], v[180:183]
 ds_read_b128 a[192:195], v4 offset:57344
 v_fmac_f32_dpp v32, v156, v16 row_shl:1 row_mask:0xf bank_mask:0xf bound_ctrl:0
 v_mfma_f32_16x16x32_bf16 v[180:183], a[156:159], a[172:175], v[180:183]
 ds_read_b128 a[196:199], v5 offset:57344
 v_fmac_f32_dpp v33, v157, v17 row_shl:1 row_mask:0xf bank_mask:0xf bound_ctrl:0
 v_mfma_f32_16x16x32_bf16 v[176:179], a[100:103], a[172:175], v[176:179]
 v_fmac_f32_dpp v34, v158, v18 row_shl:1 row_mask:0xf bank_mask:0xf bound_ctrl:0
 v_fmac_f32_dpp v35, v159, v19 row_shl:1 row_mask:0xf bank_mask:0xf bound_ctrl:0
 v_mfma_f32_16x16x32_bf16 v[176:179], a[96:99], a[168:171], v[176:179]
 v_exp_f32 v40, v32
 v_mfma_f32_16x16x32_bf16 v[172:175], a[40:43], a[168:171], v[172:175]
 v_exp_f32 v41, v33
 v_mfma_f32_16x16x32_bf16 v[172:175], a[44:47], a[172:175], v[172:175]
 v_exp_f32 v42, v34
 v_mfma_f32_16x16x32_bf16 v[172:175], a[48:51], a[176:179], v[172:175]
 v_exp_f32 v43, v35
 v_mfma_f32_16x16x32_bf16 v[172:175], a[52:55], a[180:183], v[172:175]
 ds_read_b128 a[168:171], v4 offset:61440
 v_fma_f32 v40, v40, s53, s53
 v_mfma_f32_16x16x32_bf16 v[176:179], a[108:111], a[180:183], v[176:179]
 ds_read_b128 a[172:175], v5 offset:61440
 v_fma_f32 v41, v41, s53, s53
 v_mfma_f32_16x16x32_bf16 v[176:179], a[104:107], a[176:179], v[176:179]
 v_fma_f32 v42, v42, s53, s53
 v_fma_f32 v43, v43, s53, s53
 v_mfma_f32_16x16x32_bf16 v[180:183], a[160:163], a[176:179], v[180:183]
 global_load_lds_dwordx4 v241, s[58:59]
 v_mfma_f32_16x16x32_bf16 v[180:183], a[164:167], a[180:183], v[180:183]
 s_waitcnt lgkmcnt(3)
 v_rcp_f32 v40, v40
 v_mfma_f32_16x16x32_bf16 v[184:187], a[0:3], a[184:187], 0
 s_add_u32 m0, s52, 114688
 v_rcp_f32 v41, v41
 v_mfma_f32_16x16x32_bf16 v[184:187], a[4:7], a[188:191], v[184:187]
 v_rcp_f32 v42, v42
 v_mfma_f32_16x16x32_bf16 v[188:191], a[60:63], a[188:191], 0
 v_rcp_f32 v43, v43
 v_mfma_f32_16x16x32_bf16 v[188:191], a[56:59], a[184:187], v[188:191]
 ds_read_b128 a[176:179], v6 offset:0
 v_mul_f32 v40, v40, v32
 v_mfma_f32_16x16x32_bf16 v[192:195], a[112:115], a[184:187], 0
 global_load_lds_dwordx4 v242, s[58:59]
 v_mfma_f32_16x16x32_bf16 v[192:195], a[116:119], a[188:191], v[192:195]
 s_waitcnt lgkmcnt(2)
 ds_read_b128 a[180:183], v7 offset:0
 v_mul_f32 v41, v41, v33
 v_mfma_f32_16x16x32_bf16 v[192:195], a[120:123], a[192:195], v[192:195]
 s_add_u32 m0, s52, 118784
 ds_read_b128 a[184:187], v6 offset:4096
 v_mul_f32 v42, v42, v34
 v_mfma_f32_16x16x32_bf16 v[192:195], a[124:127], a[196:199], v[192:195]
 ds_read_b128 a[188:191], v7 offset:4096
 v_mul_f32 v43, v43, v35
 v_mfma_f32_16x16x32_bf16 v[188:191], a[68:71], a[196:199], v[188:191]
 v_cvt_pk_bf16_f32 v46, v40, v41
 v_cvt_pk_bf16_f32 v47, v42, v43
 v_mfma_f32_16x16x32_bf16 v[188:191], a[64:67], a[192:195], v[188:191]
 ds_write_b64 v13, v[46:47] offset:6144
 v_mfma_f32_16x16x32_bf16 v[184:187], a[8:11], a[192:195], v[184:187]
 global_load_lds_dwordx4 v243, s[58:59]
 v_mfma_f32_16x16x32_bf16 v[184:187], a[12:15], a[196:199], v[184:187]
 s_add_u32 m0, s52, 122880
 v_fma_f32 v28, v164, v16, v20
 v_fma_f32 v29, v165, v17, v21
 v_mfma_f32_16x16x32_bf16 v[184:187], a[16:19], a[168:171], v[184:187]
 s_waitcnt lgkmcnt(3)
 ds_read_b128 a[192:195], v4 offset:53248
 v_fma_f32 v30, v166, v18, v22
 v_mfma_f32_16x16x32_bf16 v[184:187], a[20:23], a[172:175], v[184:187]
 ds_read_b128 a[196:199], v5 offset:53248
 v_fma_f32 v31, v167, v19, v23
 v_mfma_f32_16x16x32_bf16 v[188:191], a[76:79], a[172:175], v[188:191]
 v_fmac_f32_dpp v28, v160, v16 row_shr:1 row_mask:0xf bank_mask:0xf bound_ctrl:0
 v_fmac_f32_dpp v29, v161, v17 row_shr:1 row_mask:0xf bank_mask:0xf bound_ctrl:0
 v_mfma_f32_16x16x32_bf16 v[188:191], a[72:75], a[168:171], v[188:191]
 v_fmac_f32_dpp v30, v162, v18 row_shr:1 row_mask:0xf bank_mask:0xf bound_ctrl:0
 v_fmac_f32_dpp v31, v163, v19 row_shr:1 row_mask:0xf bank_mask:0xf bound_ctrl:0
 v_mfma_f32_16x16x32_bf16 v[192:195], a[128:131], a[168:171], v[192:195]
 global_load_lds_dwordx4 v244, s[58:59]
 v_mfma_f32_16x16x32_bf16 v[192:195], a[132:135], a[172:175], v[192:195]
 s_add_u32 m0, s52, 126976
 v_fmac_f32_dpp v28, v168, v16 row_shl:1 row_mask:0xf bank_mask:0xf bound_ctrl:0
 v_fmac_f32_dpp v29, v169, v17 row_shl:1 row_mask:0xf bank_mask:0xf bound_ctrl:0
 v_mfma_f32_16x16x32_bf16 v[192:195], a[136:139], a[176:179], v[192:195]
 ds_read_b128 a[168:171], v6 offset:12288
 v_fmac_f32_dpp v30, v170, v18 row_shl:1 row_mask:0xf bank_mask:0xf bound_ctrl:0
 v_mfma_f32_16x16x32_bf16 v[192:195], a[140:143], a[180:183], v[192:195]
 ds_read_b128 a[172:175], v7 offset:12288
 v_fmac_f32_dpp v31, v171, v19 row_shl:1 row_mask:0xf bank_mask:0xf bound_ctrl:0
 v_mfma_f32_16x16x32_bf16 v[188:191], a[84:87], a[180:183], v[188:191]
 v_exp_f32 v36, v28
 v_mfma_f32_16x16x32_bf16 v[188:191], a[80:83], a[176:179], v[188:191]
 v_exp_f32 v37, v29
 v_mfma_f32_16x16x32_bf16 v[184:187], a[24:27], a[176:179], v[184:187]
 global_load_lds_dwordx4 v245, s[58:59]
 v_mfma_f32_16x16x32_bf16 v[184:187], a[28:31], a[180:183], v[184:187]
 s_waitcnt lgkmcnt(3)
 v_exp_f32 v38, v30
 v_mfma_f32_16x16x32_bf16 v[184:187], a[32:35], a[184:187], v[184:187]
 s_add_u32 m0, s52, 110592
 v_exp_f32 v39, v31
 v_mfma_f32_16x16x32_bf16 v[184:187], a[36:39], a[188:191], v[184:187]
 ds_read_b128 a[176:179], v4 offset:22528
 v_fma_f32 v36, v36, s53, s53
 v_mfma_f32_16x16x32_bf16 v[188:191], a[92:95], a[188:191], v[188:191]
 ds_read_b128 a[180:183], v5 offset:22528
 v_fma_f32 v37, v37, s53, s53
 v_mfma_f32_16x16x32_bf16 v[188:191], a[88:91], a[184:187], v[188:191]
 v_fma_f32 v38, v38, s53, s53
 v_fma_f32 v39, v39, s53, s53
 v_mfma_f32_16x16x32_bf16 v[192:195], a[144:147], a[184:187], v[192:195]
 global_load_lds_dwordx4 v246, s[58:59]
 v_mfma_f32_16x16x32_bf16 v[192:195], a[148:151], a[188:191], v[192:195]
 s_add_u32 m0, s52, 131072
 v_rcp_f32 v36, v36
 v_mfma_f32_16x16x32_bf16 v[192:195], a[152:155], a[192:195], v[192:195]
 s_waitcnt lgkmcnt(2)
 v_rcp_f32 v37, v37
 v_mfma_f32_16x16x32_bf16 v[192:195], a[156:159], a[196:199], v[192:195]
 s_mov_b32 s60, s4
 v_rcp_f32 v38, v38
 v_mfma_f32_16x16x32_bf16 v[188:191], a[100:103], a[196:199], v[188:191]
 v_rcp_f32 v39, v39
 v_mfma_f32_16x16x32_bf16 v[188:191], a[96:99], a[192:195], v[188:191]
 ds_read_b128 a[184:187], v4 offset:59392
 v_mul_f32 v36, v36, v28
 v_mfma_f32_16x16x32_bf16 v[184:187], a[40:43], a[192:195], v[184:187]
 ds_read_b128 a[188:191], v5 offset:59392
 v_mul_f32 v37, v37, v29
 v_mfma_f32_16x16x32_bf16 v[184:187], a[44:47], a[196:199], v[184:187]
 buffer_store_dwordx4 v[52:55], v3, s[28:31], s61 offen sc1
 v_mfma_f32_16x16x32_bf16 v[184:187], a[48:51], a[168:171], v[184:187]
 ds_read_b128 a[192:195], v4 offset:63488
 v_mul_f32 v38, v38, v30
 v_mfma_f32_16x16x32_bf16 v[184:187], a[52:55], a[172:175], v[184:187]
 ds_read_b128 a[196:199], v5 offset:63488
 v_mul_f32 v39, v39, v31
 v_mfma_f32_16x16x32_bf16 v[188:191], a[108:111], a[172:175], v[188:191]
 ds_read_b128 v[48:51], v14 offset:0
 v_cvt_pk_bf16_f32 v44, v36, v37
 v_mfma_f32_16x16x32_bf16 v[188:191], a[104:107], a[168:171], v[188:191]
 s_add_u32 s61, s51, 229376
 v_cvt_pk_bf16_f32 v45, v38, v39
 v_fma_f32 v32, v176, v16, v20
 v_mfma_f32_16x16x32_bf16 v[192:195], a[160:163], a[168:171], v[192:195]
 ds_write_b64 v13, v[44:45] offset:8192
 v_mfma_f32_16x16x32_bf16 v[192:195], a[164:167], a[172:175], v[192:195]
 s_waitcnt lgkmcnt(5)
 v_fma_f32 v33, v177, v17, v21
 v_fma_f32 v34, v178, v18, v22
 v_mfma_f32_16x16x32_bf16 v[196:199], a[0:3], a[176:179], 0
 ds_read_b128 a[168:171], v6 offset:2048
 v_fma_f32 v35, v179, v19, v23
 v_mfma_f32_16x16x32_bf16 v[196:199], a[4:7], a[180:183], v[196:199]
 ds_read_b128 a[172:175], v7 offset:2048
 v_fmac_f32_dpp v32, v172, v16 row_shr:1 row_mask:0xf bank_mask:0xf bound_ctrl:0
 v_mfma_f32_16x16x32_bf16 v[200:203], a[60:63], a[180:183], 0
 s_waitcnt lgkmcnt(3)
 v_fmac_f32_dpp v33, v173, v17 row_shr:1 row_mask:0xf bank_mask:0xf bound_ctrl:0
 v_fmac_f32_dpp v34, v174, v18 row_shr:1 row_mask:0xf bank_mask:0xf bound_ctrl:0
 v_mfma_f32_16x16x32_bf16 v[200:203], a[56:59], a[176:179], v[200:203]
 buffer_store_dwordx4 v[48:51], v3, s[28:31], s61 offen sc1
 v_mfma_f32_16x16x32_bf16 v[204:207], a[112:115], a[176:179], 0
 v_fmac_f32_dpp v35, v175, v19 row_shr:1 row_mask:0xf bank_mask:0xf bound_ctrl:0
 v_fmac_f32_dpp v32, v180, v16 row_shl:1 row_mask:0xf bank_mask:0xf bound_ctrl:0
 v_mfma_f32_16x16x32_bf16 v[204:207], a[116:119], a[180:183], v[204:207]
 v_fmac_f32_dpp v33, v181, v17 row_shl:1 row_mask:0xf bank_mask:0xf bound_ctrl:0
 v_fmac_f32_dpp v34, v182, v18 row_shl:1 row_mask:0xf bank_mask:0xf bound_ctrl:0
 v_mfma_f32_16x16x32_bf16 v[204:207], a[120:123], a[184:187], v[204:207]
 ds_read_b128 a[176:179], v6 offset:6144
 v_fmac_f32_dpp v35, v183, v19 row_shl:1 row_mask:0xf bank_mask:0xf bound_ctrl:0
 v_mfma_f32_16x16x32_bf16 v[204:207], a[124:127], a[188:191], v[204:207]
 v_exp_f32 v40, v32
 v_mfma_f32_16x16x32_bf16 v[200:203], a[68:71], a[188:191], v[200:203]
 v_exp_f32 v41, v33
 v_mfma_f32_16x16x32_bf16 v[200:203], a[64:67], a[184:187], v[200:203]
 v_exp_f32 v42, v34
 v_mfma_f32_16x16x32_bf16 v[196:199], a[8:11], a[184:187], v[196:199]
 v_exp_f32 v43, v35
 v_mfma_f32_16x16x32_bf16 v[196:199], a[12:15], a[188:191], v[196:199]
 ds_read_b128 a[180:183], v7 offset:6144
 v_fma_f32 v40, v40, s53, s53
 v_mfma_f32_16x16x32_bf16 v[196:199], a[16:19], a[192:195], v[196:199]
 ds_read_b128 a[184:187], v4 offset:55296
 v_fma_f32 v41, v41, s53, s53
 v_mfma_f32_16x16x32_bf16 v[196:199], a[20:23], a[196:199], v[196:199]
 ds_read_b128 a[188:191], v5 offset:55296
 v_fma_f32 v42, v42, s53, s53
 v_mfma_f32_16x16x32_bf16 v[200:203], a[76:79], a[196:199], v[200:203]
 v_fma_f32 v43, v43, s53, s53
 v_mfma_f32_16x16x32_bf16 v[200:203], a[72:75], a[192:195], v[200:203]
 v_rcp_f32 v40, v40
 v_mfma_f32_16x16x32_bf16 v[204:207], a[128:131], a[192:195], v[204:207]
 v_rcp_f32 v41, v41
 v_mfma_f32_16x16x32_bf16 v[204:207], a[132:135], a[196:199], v[204:207]
 s_waitcnt lgkmcnt(3)
 v_rcp_f32 v42, v42
 v_mfma_f32_16x16x32_bf16 v[204:207], a[136:139], a[168:171], v[204:207]
 v_rcp_f32 v43, v43
 v_mfma_f32_16x16x32_bf16 v[204:207], a[140:143], a[172:175], v[204:207]
 ds_read_b128 a[192:195], v6 offset:14336
 v_mul_f32 v40, v40, v32
 v_mfma_f32_16x16x32_bf16 v[200:203], a[84:87], a[172:175], v[200:203]
 s_waitcnt vmcnt(9)
 ds_read_b128 a[196:199], v7 offset:14336
 v_mul_f32 v41, v41, v33
 v_mfma_f32_16x16x32_bf16 v[200:203], a[80:83], a[168:171], v[200:203]
 s_barrier
 v_mfma_f32_16x16x32_bf16 v[196:199], a[24:27], a[168:171], v[196:199]
 ds_read_b128 v[52:55], v14 offset:4096
 v_mul_f32 v42, v42, v34
 v_mfma_f32_16x16x32_bf16 v[196:199], a[28:31], a[172:175], v[196:199]
 s_waitcnt lgkmcnt(4)
 v_mul_f32 v43, v43, v35
 v_cvt_pk_bf16_f32 v46, v40, v41
 v_mfma_f32_16x16x32_bf16 v[196:199], a[32:35], a[176:179], v[196:199]
 s_add_u32 s61, s51, 258048
 ds_read_b128 a[168:171], v4 offset:49152
 v_cvt_pk_bf16_f32 v47, v42, v43
 v_mfma_f32_16x16x32_bf16 v[196:199], a[36:39], a[180:183], v[196:199]
 ds_write_b64 v13, v[46:47] offset:10240
 v_mfma_f32_16x16x32_bf16 v[200:203], a[92:95], a[180:183], v[200:203]
 ds_read_b128 a[172:175], v5 offset:49152
 v_fma_f32 v28, v188, v16, v20
 v_mfma_f32_16x16x32_bf16 v[200:203], a[88:91], a[176:179], v[200:203]
 v_fma_f32 v29, v189, v17, v21
 v_fma_f32 v30, v190, v18, v22
 v_mfma_f32_16x16x32_bf16 v[204:207], a[144:147], a[176:179], v[204:207]
 s_waitcnt lgkmcnt(3)
 v_fma_f32 v31, v191, v19, v23
 v_fmac_f32_dpp v28, v184, v16 row_shr:1 row_mask:0xf bank_mask:0xf bound_ctrl:0
 v_mfma_f32_16x16x32_bf16 v[204:207], a[148:151], a[180:183], v[204:207]
 v_fmac_f32_dpp v29, v185, v17 row_shr:1 row_mask:0xf bank_mask:0xf bound_ctrl:0
 v_fmac_f32_dpp v30, v186, v18 row_shr:1 row_mask:0xf bank_mask:0xf bound_ctrl:0
 v_mfma_f32_16x16x32_bf16 v[204:207], a[152:155], a[184:187], v[204:207]
 ds_read_b128 a[176:179], v6 offset:20480
 v_fmac_f32_dpp v31, v187, v19 row_shr:1 row_mask:0xf bank_mask:0xf bound_ctrl:0
 v_mfma_f32_16x16x32_bf16 v[204:207], a[156:159], a[188:191], v[204:207]
 ds_read_b128 a[180:183], v7 offset:20480
 v_fmac_f32_dpp v28, v192, v16 row_shl:1 row_mask:0xf bank_mask:0xf bound_ctrl:0
 v_mfma_f32_16x16x32_bf16 v[200:203], a[100:103], a[188:191], v[200:203]
 v_fmac_f32_dpp v29, v193, v17 row_shl:1 row_mask:0xf bank_mask:0xf bound_ctrl:0
 v_fmac_f32_dpp v30, v194, v18 row_shl:1 row_mask:0xf bank_mask:0xf bound_ctrl:0
 v_mfma_f32_16x16x32_bf16 v[200:203], a[96:99], a[184:187], v[200:203]
 v_fmac_f32_dpp v31, v195, v19 row_shl:1 row_mask:0xf bank_mask:0xf bound_ctrl:0
 v_mfma_f32_16x16x32_bf16 v[196:199], a[40:43], a[184:187], v[196:199]
 v_exp_f32 v36, v28
 v_mfma_f32_16x16x32_bf16 v[196:199], a[44:47], a[188:191], v[196:199]
 v_exp_f32 v37, v29
 v_mfma_f32_16x16x32_bf16 v[196:199], a[48:51], a[192:195], v[196:199]
 v_exp_f32 v38, v30
 v_mfma_f32_16x16x32_bf16 v[196:199], a[52:55], a[196:199], v[196:199]
 v_exp_f32 v39, v31
 v_mfma_f32_16x16x32_bf16 v[200:203], a[108:111], a[196:199], v[200:203]
 ds_read_b128 a[184:187], v6 offset:24576
 v_fma_f32 v36, v36, s53, s53
 v_mfma_f32_16x16x32_bf16 v[200:203], a[104:107], a[192:195], v[200:203]
 ds_read_b128 a[188:191], v7 offset:24576
 v_fma_f32 v37, v37, s53, s53
 v_mfma_f32_16x16x32_bf16 v[204:207], a[160:163], a[192:195], v[204:207]
 buffer_load_dwordx4 v1, s[20:23], s60 offen lds
 v_mfma_f32_16x16x32_bf16 v[204:207], a[164:167], a[196:199], v[204:207]
 s_waitcnt lgkmcnt(3)
 v_fma_f32 v38, v38, s53, s53
 v_fma_f32 v39, v39, s53, s53
 v_mfma_f32_16x16x32_bf16 v[64:67], a[0:3], a[168:171], 0
 s_add_u32 m0, s52, 135168
 v_rcp_f32 v36, v36
 v_mfma_f32_16x16x32_bf16 v[64:67], a[4:7], a[172:175], v[64:67]
 s_mov_b32 s60, s5
 v_rcp_f32 v37, v37
 v_mfma_f32_16x16x32_bf16 v[68:71], a[60:63], a[172:175], 0
 v_rcp_f32 v38, v38
 v_mfma_f32_16x16x32_bf16 v[68:71], a[56:59], a[168:171], v[68:71]
 v_rcp_f32 v39, v39
 v_mfma_f32_16x16x32_bf16 v[72:75], a[112:115], a[168:171], 0
 buffer_load_dwordx4 v1, s[20:23], s60 offen lds
 v_mfma_f32_16x16x32_bf16 v[72:75], a[116:119], a[172:175], v[72:75]
 s_add_u32 m0, s52, 143360
 ds_read_b128 a[192:195], v6 offset:28672
 v_mul_f32 v36, v36, v28
 v_mfma_f32_16x16x32_bf16 v[72:75], a[120:123], a[176:179], v[72:75]
 s_waitcnt lgkmcnt(1)
 ds_read_b128 a[196:199], v7 offset:28672
 v_mul_f32 v37, v37, v29
 v_mfma_f32_16x16x32_bf16 v[72:75], a[124:127], a[180:183], v[72:75]
 s_mov_b32 s60, s6
 ds_read_b128 a[168:171], v6 offset:16384
 v_mul_f32 v38, v38, v30
 v_mfma_f32_16x16x32_bf16 v[68:71], a[68:71], a[180:183], v[68:71]
 ds_read_b128 a[172:175], v7 offset:16384
 v_mul_f32 v39, v39, v31
 v_mfma_f32_16x16x32_bf16 v[68:71], a[64:67], a[176:179], v[68:71]
 v_cvt_pk_bf16_f32 v44, v36, v37
 v_cvt_pk_bf16_f32 v45, v38, v39
 v_mfma_f32_16x16x32_bf16 v[64:67], a[8:11], a[176:179], v[64:67]
 buffer_load_dwordx4 v1, s[20:23], s60 offen lds
 v_mfma_f32_16x16x32_bf16 v[64:67], a[12:15], a[180:183], v[64:67]
 s_add_u32 m0, s52, 0
 ds_write_b64 v13, v[44:45] offset:12288
 v_mfma_f32_16x16x32_bf16 v[64:67], a[16:19], a[184:187], v[64:67]
 buffer_store_dwordx4 v[52:55], v3, s[28:31], s61 offen sc1
 v_mfma_f32_16x16x32_bf16 v[64:67], a[20:23], a[188:191], v[64:67]
 s_mov_b32 s60, s7
 ds_read_b128 a[176:179], v6 offset:32768
 v_fma_f32 v32, v200, v16, v20
 v_mfma_f32_16x16x32_bf16 v[68:71], a[76:79], a[188:191], v[68:71]
 ds_read_b128 a[180:183], v7 offset:32768
 v_fma_f32 v33, v201, v17, v21
 v_mfma_f32_16x16x32_bf16 v[68:71], a[72:75], a[184:187], v[68:71]
 v_fma_f32 v34, v202, v18, v22
 v_fma_f32 v35, v203, v19, v23
 v_mfma_f32_16x16x32_bf16 v[72:75], a[128:131], a[184:187], v[72:75]
 buffer_load_dwordx4 v1, s[20:23], s60 offen lds
 v_mfma_f32_16x16x32_bf16 v[72:75], a[132:135], a[188:191], v[72:75]
 s_waitcnt lgkmcnt(4)
 v_fmac_f32_dpp v32, v196, v16 row_shr:1 row_mask:0xf bank_mask:0xf bound_ctrl:0
 v_fmac_f32_dpp v33, v197, v17 row_shr:1 row_mask:0xf bank_mask:0xf bound_ctrl:0
 v_mfma_f32_16x16x32_bf16 v[72:75], a[136:139], a[192:195], v[72:75]
 ds_read_b128 a[184:187], v6 offset:36864
 v_fmac_f32_dpp v34, v198, v18 row_shr:1 row_mask:0xf bank_mask:0xf bound_ctrl:0
 v_mfma_f32_16x16x32_bf16 v[72:75], a[140:143], a[196:199], v[72:75]
 ds_read_b128 a[188:191], v7 offset:36864
 v_fmac_f32_dpp v35, v199, v19 row_shr:1 row_mask:0xf bank_mask:0xf bound_ctrl:0
 v_mfma_f32_16x16x32_bf16 v[68:71], a[84:87], a[196:199], v[68:71]
 v_fmac_f32_dpp v32, v204, v16 row_shl:1 row_mask:0xf bank_mask:0xf bound_ctrl:0
 v_fmac_f32_dpp v33, v205, v17 row_shl:1 row_mask:0xf bank_mask:0xf bound_ctrl:0
 v_mfma_f32_16x16x32_bf16 v[68:71], a[80:83], a[192:195], v[68:71]
 v_fmac_f32_dpp v34, v206, v18 row_shl:1 row_mask:0xf bank_mask:0xf bound_ctrl:0
 v_fmac_f32_dpp v35, v207, v19 row_shl:1 row_mask:0xf bank_mask:0xf bound_ctrl:0
 v_mfma_f32_16x16x32_bf16 v[64:67], a[24:27], a[192:195], v[64:67]
 v_exp_f32 v40, v32
 v_mfma_f32_16x16x32_bf16 v[64:67], a[28:31], a[196:199], v[64:67]
 v_exp_f32 v41, v33
 v_mfma_f32_16x16x32_bf16 v[64:67], a[32:35], a[168:171], v[64:67]
 s_waitcnt lgkmcnt(2)
 v_exp_f32 v42, v34
 v_mfma_f32_16x16x32_bf16 v[64:67], a[36:39], a[172:175], v[64:67]
 v_exp_f32 v43, v35
 v_mfma_f32_16x16x32_bf16 v[68:71], a[92:95], a[172:175], v[68:71]
 ds_read_b128 a[192:195], v4 offset:51200
 v_fma_f32 v40, v40, s53, s53
 v_mfma_f32_16x16x32_bf16 v[68:71], a[88:91], a[168:171], v[68:71]
 ds_read_b128 a[196:199], v5 offset:51200
 v_fma_f32 v41, v41, s53, s53
 v_mfma_f32_16x16x32_bf16 v[72:75], a[144:147], a[168:171], v[72:75]
 v_fma_f32 v42, v42, s53, s53
 v_fma_f32 v43, v43, s53, s53
 v_mfma_f32_16x16x32_bf16 v[72:75], a[148:151], a[172:175], v[72:75]
 v_rcp_f32 v40, v40
 v_mfma_f32_16x16x32_bf16 v[72:75], a[152:155], a[176:179], v[72:75]
 v_rcp_f32 v41, v41
 v_mfma_f32_16x16x32_bf16 v[72:75], a[156:159], a[180:183], v[72:75]
 v_rcp_f32 v42, v42
 v_mfma_f32_16x16x32_bf16 v[68:71], a[100:103], a[180:183], v[68:71]
 v_rcp_f32 v43, v43
 v_mfma_f32_16x16x32_bf16 v[68:71], a[96:99], a[176:179], v[68:71]
 ds_read_b128 a[168:171], v6 offset:22528
 v_mul_f32 v40, v40, v32
 v_mfma_f32_16x16x32_bf16 v[64:67], a[40:43], a[176:179], v[64:67]
 ds_read_b128 a[172:175], v7 offset:22528
 v_mul_f32 v41, v41, v33
 v_mfma_f32_16x16x32_bf16 v[64:67], a[44:47], a[180:183], v[64:67]
 s_waitcnt lgkmcnt(3)
 v_mul_f32 v42, v42, v34
 v_mul_f32 v43, v43, v35
 v_mfma_f32_16x16x32_bf16 v[64:67], a[48:51], a[184:187], v[64:67]
 ds_read_b128 a[176:179], v6 offset:26624
 v_cvt_pk_bf16_f32 v46, v40, v41
 v_mfma_f32_16x16x32_bf16 v[64:67], a[52:55], a[188:191], v[64:67]
 ds_read_b128 a[180:183], v7 offset:26624
 v_cvt_pk_bf16_f32 v47, v42, v43
 v_mfma_f32_16x16x32_bf16 v[68:71], a[108:111], a[188:191], v[68:71]
 ds_write_b64 v13, v[46:47] offset:14336
 v_mfma_f32_16x16x32_bf16 v[68:71], a[104:107], a[184:187], v[68:71]
 v_mfma_f32_16x16x32_bf16 v[72:75], a[160:163], a[184:187], v[72:75]
 v_mfma_f32_16x16x32_bf16 v[72:75], a[164:167], a[188:191], v[72:75]
 s_waitcnt lgkmcnt(4)
 v_mfma_f32_16x16x32_bf16 v[76:79], a[0:3], a[192:195], 0
 ds_read_b128 a[184:187], v6 offset:30720
 v_mfma_f32_16x16x32_bf16 v[76:79], a[4:7], a[196:199], v[76:79]
 ds_read_b128 a[188:191], v7 offset:30720
 v_mfma_f32_16x16x32_bf16 v[80:83], a[60:63], a[196:199], 0
 v_fma_f32 v28, v68, v16, v20
 v_fma_f32 v29, v69, v17, v21
 v_mfma_f32_16x16x32_bf16 v[80:83], a[56:59], a[192:195], v[80:83]
 v_fma_f32 v30, v70, v18, v22
 v_fma_f32 v31, v71, v19, v23
 v_mfma_f32_16x16x32_bf16 v[84:87], a[112:115], a[192:195], 0
 v_fmac_f32_dpp v28, v64, v16 row_shr:1 row_mask:0xf bank_mask:0xf bound_ctrl:0
 v_fmac_f32_dpp v29, v65, v17 row_shr:1 row_mask:0xf bank_mask:0xf bound_ctrl:0
 v_mfma_f32_16x16x32_bf16 v[84:87], a[116:119], a[196:199], v[84:87]
 v_fmac_f32_dpp v30, v66, v18 row_shr:1 row_mask:0xf bank_mask:0xf bound_ctrl:0
 v_fmac_f32_dpp v31, v67, v19 row_shr:1 row_mask:0xf bank_mask:0xf bound_ctrl:0
 v_mfma_f32_16x16x32_bf16 v[84:87], a[120:123], a[168:171], v[84:87]
 s_waitcnt lgkmcnt(3)
 ds_read_b128 a[192:195], v6 offset:18432
 v_fmac_f32_dpp v28, v72, v16 row_shl:1 row_mask:0xf bank_mask:0xf bound_ctrl:0
 v_mfma_f32_16x16x32_bf16 v[84:87], a[124:127], a[172:175], v[84:87]
 ds_read_b128 a[196:199], v7 offset:18432
 v_fmac_f32_dpp v29, v73, v17 row_shl:1 row_mask:0xf bank_mask:0xf bound_ctrl:0
 v_mfma_f32_16x16x32_bf16 v[80:83], a[68:71], a[172:175], v[80:83]
 v_fmac_f32_dpp v30, v74, v18 row_shl:1 row_mask:0xf bank_mask:0xf bound_ctrl:0
 v_fmac_f32_dpp v31, v75, v19 row_shl:1 row_mask:0xf bank_mask:0xf bound_ctrl:0
 v_mfma_f32_16x16x32_bf16 v[80:83], a[64:67], a[168:171], v[80:83]
 v_exp_f32 v36, v28
 v_mfma_f32_16x16x32_bf16 v[76:79], a[8:11], a[168:171], v[76:79]
 v_exp_f32 v37, v29
 v_mfma_f32_16x16x32_bf16 v[76:79], a[12:15], a[172:175], v[76:79]
 v_exp_f32 v38, v30
 v_mfma_f32_16x16x32_bf16 v[76:79], a[16:19], a[176:179], v[76:79]
 v_exp_f32 v39, v31
 v_mfma_f32_16x16x32_bf16 v[76:79], a[20:23], a[180:183], v[76:79]
 ds_read_b128 a[168:171], v6 offset:34816
 v_fma_f32 v36, v36, s53, s53
 v_mfma_f32_16x16x32_bf16 v[80:83], a[76:79], a[180:183], v[80:83]
 ds_read_b128 a[172:175], v7 offset:34816
 v_fma_f32 v37, v37, s53, s53
 v_mfma_f32_16x16x32_bf16 v[80:83], a[72:75], a[176:179], v[80:83]
 v_fma_f32 v38, v38, s53, s53
 v_fma_f32 v39, v39, s53, s53
 v_mfma_f32_16x16x32_bf16 v[84:87], a[128:131], a[176:179], v[84:87]
 v_rcp_f32 v36, v36
 v_mfma_f32_16x16x32_bf16 v[84:87], a[132:135], a[180:183], v[84:87]
 s_waitcnt lgkmcnt(3)
 v_rcp_f32 v37, v37
 v_mfma_f32_16x16x32_bf16 v[84:87], a[136:139], a[184:187], v[84:87]
 v_rcp_f32 v38, v38
 v_mfma_f32_16x16x32_bf16 v[84:87], a[140:143], a[188:191], v[84:87]
 v_rcp_f32 v39, v39
 v_mfma_f32_16x16x32_bf16 v[80:83], a[84:87], a[188:191], v[80:83]
 s_waitcnt vmcnt(7)
 ds_read_b128 a[176:179], v6 offset:38912
 v_mul_f32 v36, v36, v28
 v_mfma_f32_16x16x32_bf16 v[80:83], a[80:83], a[184:187], v[80:83]
 s_barrier
 v_mfma_f32_16x16x32_bf16 v[76:79], a[24:27], a[184:187], v[76:79]
 ds_read_b128 a[180:183], v7 offset:38912
 v_mul_f32 v37, v37, v29
 v_mfma_f32_16x16x32_bf16 v[76:79], a[28:31], a[188:191], v[76:79]
 ds_read_b128 v[48:51], v14 offset:8192
 v_mul_f32 v38, v38, v30
 v_mfma_f32_16x16x32_bf16 v[76:79], a[32:35], a[192:195], v[76:79]
 s_waitcnt lgkmcnt(3)
 ds_read_b128 a[184:187], v6 offset:8192
 v_mul_f32 v39, v39, v31
 v_mfma_f32_16x16x32_bf16 v[76:79], a[36:39], a[196:199], v[76:79]
 s_add_u32 s61, s51, 286720
 ds_read_b128 a[188:191], v7 offset:8192
 v_cvt_pk_bf16_f32 v44, v36, v37
 v_mfma_f32_16x16x32_bf16 v[80:83], a[92:95], a[196:199], v[80:83]
 v_cvt_pk_bf16_f32 v45, v38, v39
 v_mfma_f32_16x16x32_bf16 v[80:83], a[88:91], a[192:195], v[80:83]
 ds_write_b64 v13, v[44:45] offset:0
 v_mfma_f32_16x16x32_bf16 v[84:87], a[144:147], a[192:195], v[84:87]
 v_mfma_f32_16x16x32_bf16 v[84:87], a[148:151], a[196:199], v[84:87]
 s_waitcnt lgkmcnt(3)
 v_mfma_f32_16x16x32_bf16 v[84:87], a[152:155], a[168:171], v[84:87]
 buffer_store_dwordx4 v[48:51], v3, s[28:31], s61 offen sc1
 v_mfma_f32_16x16x32_bf16 v[84:87], a[156:159], a[172:175], v[84:87]
 ds_read_b128 a[192:195], v6 offset:40960
 v_mfma_f32_16x16x32_bf16 v[80:83], a[100:103], a[172:175], v[80:83]
 ds_read_b128 a[196:199], v7 offset:40960
 v_mfma_f32_16x16x32_bf16 v[80:83], a[96:99], a[168:171], v[80:83]
 ds_read_b128 v[52:55], v14 offset:12288
 v_mfma_f32_16x16x32_bf16 v[76:79], a[40:43], a[168:171], v[76:79]
 s_add_u32 s61, s51, 315392
 v_mfma_f32_16x16x32_bf16 v[76:79], a[44:47], a[172:175], v[76:79]
 v_mfma_f32_16x16x32_bf16 v[76:79], a[48:51], a[176:179], v[76:79]
 ds_read_b128 a[168:171], v6 offset:49152
 v_mfma_f32_16x16x32_bf16 v[76:79], a[52:55], a[180:183], v[76:79]
 ds_read_b128 a[172:175], v7 offset:49152
 v_mfma_f32_16x16x32_bf16 v[80:83], a[108:111], a[180:183], v[80:83]
 v_mfma_f32_16x16x32_bf16 v[80:83], a[104:107], a[176:179], v[80:83]
 s_waitcnt lgkmcnt(2)
 v_mfma_f32_16x16x32_bf16 v[84:87], a[160:163], a[176:179], v[84:87]
 buffer_store_dwordx4 v[52:55], v3, s[28:31], s61 offen sc1
 v_mfma_f32_16x16x32_bf16 v[84:87], a[164:167], a[180:183], v[84:87]
 v_mfma_f32_16x16x32_bf16 v[88:91], a[0:3], a[184:187], 0
 ds_read_b128 a[176:179], v6 offset:53248
 v_mfma_f32_16x16x32_bf16 v[88:91], a[4:7], a[188:191], v[88:91]
 ds_read_b128 a[180:183], v7 offset:53248
 v_mfma_f32_16x16x32_bf16 v[92:95], a[60:63], a[188:191], 0
 v_fma_f32 v32, v80, v16, v20
 v_fma_f32 v33, v81, v17, v21
 v_mfma_f32_16x16x32_bf16 v[92:95], a[56:59], a[184:187], v[92:95]
 v_fma_f32 v34, v82, v18, v22
 v_fma_f32 v35, v83, v19, v23
 v_mfma_f32_16x16x32_bf16 v[96:99], a[112:115], a[184:187], 0
 v_fmac_f32_dpp v32, v76, v16 row_shr:1 row_mask:0xf bank_mask:0xf bound_ctrl:0
 v_fmac_f32_dpp v33, v77, v17 row_shr:1 row_mask:0xf bank_mask:0xf bound_ctrl:0
 v_mfma_f32_16x16x32_bf16 v[96:99], a[116:119], a[188:191], v[96:99]
 v_fmac_f32_dpp v34, v78, v18 row_shr:1 row_mask:0xf bank_mask:0xf bound_ctrl:0
 v_fmac_f32_dpp v35, v79, v19 row_shr:1 row_mask:0xf bank_mask:0xf bound_ctrl:0
 v_mfma_f32_16x16x32_bf16 v[96:99], a[120:123], a[192:195], v[96:99]
 ds_read_b128 a[184:187], v6 offset:57344
 v_fmac_f32_dpp v32, v84, v16 row_shl:1 row_mask:0xf bank_mask:0xf bound_ctrl:0
 v_mfma_f32_16x16x32_bf16 v[96:99], a[124:127], a[196:199], v[96:99]
 ds_read_b128 a[188:191], v7 offset:57344
 v_fmac_f32_dpp v33, v85, v17 row_shl:1 row_mask:0xf bank_mask:0xf bound_ctrl:0
 v_mfma_f32_16x16x32_bf16 v[92:95], a[68:71], a[196:199], v[92:95]
 v_fmac_f32_dpp v34, v86, v18 row_shl:1 row_mask:0xf bank_mask:0xf bound_ctrl:0
 v_fmac_f32_dpp v35, v87, v19 row_shl:1 row_mask:0xf bank_mask:0xf bound_ctrl:0
 v_mfma_f32_16x16x32_bf16 v[92:95], a[64:67], a[192:195], v[92:95]
 v_exp_f32 v40, v32
 v_mfma_f32_16x16x32_bf16 v[88:91], a[8:11], a[192:195], v[88:91]
 v_exp_f32 v41, v33
 v_mfma_f32_16x16x32_bf16 v[88:91], a[12:15], a[196:199], v[88:91]
 s_waitcnt lgkmcnt(3)
 v_exp_f32 v42, v34
 v_mfma_f32_16x16x32_bf16 v[88:91], a[16:19], a[168:171], v[88:91]
 v_exp_f32 v43, v35
 v_mfma_f32_16x16x32_bf16 v[88:91], a[20:23], a[172:175], v[88:91]
 ds_read_b128 a[192:195], v6 offset:61440
 v_fma_f32 v40, v40, s53, s53
 v_mfma_f32_16x16x32_bf16 v[92:95], a[76:79], a[172:175], v[92:95]
 ds_read_b128 a[196:199], v7 offset:61440
 v_fma_f32 v41, v41, s53, s53
 v_mfma_f32_16x16x32_bf16 v[92:95], a[72:75], a[168:171], v[92:95]
 v_fma_f32 v42, v42, s53, s53
 v_fma_f32 v43, v43, s53, s53
 v_mfma_f32_16x16x32_bf16 v[96:99], a[128:131], a[168:171], v[96:99]
 v_rcp_f32 v40, v40
 v_mfma_f32_16x16x32_bf16 v[96:99], a[132:135], a[172:175], v[96:99]
 s_waitcnt lgkmcnt(3)
 v_rcp_f32 v41, v41
 v_mfma_f32_16x16x32_bf16 v[96:99], a[136:139], a[176:179], v[96:99]
 v_rcp_f32 v42, v42
 v_mfma_f32_16x16x32_bf16 v[96:99], a[140:143], a[180:183], v[96:99]
 v_rcp_f32 v43, v43
 v_mfma_f32_16x16x32_bf16 v[92:95], a[84:87], a[180:183], v[92:95]
 ds_read_b128 a[168:171], v6 offset:45056
 v_mul_f32 v40, v40, v32
 v_mfma_f32_16x16x32_bf16 v[92:95], a[80:83], a[176:179], v[92:95]
 ds_read_b128 a[172:175], v7 offset:45056
 v_mul_f32 v41, v41, v33
 v_mfma_f32_16x16x32_bf16 v[88:91], a[24:27], a[176:179], v[88:91]
 v_mul_f32 v42, v42, v34
 v_mul_f32 v43, v43, v35
 v_mfma_f32_16x16x32_bf16 v[88:91], a[28:31], a[180:183], v[88:91]
 v_cvt_pk_bf16_f32 v46, v40, v41
 v_cvt_pk_bf16_f32 v47, v42, v43
 v_mfma_f32_16x16x32_bf16 v[88:91], a[32:35], a[184:187], v[88:91]
 s_waitcnt lgkmcnt(2)
 ds_write_b64 v13, v[46:47] offset:2048
 v_mfma_f32_16x16x32_bf16 v[88:91], a[36:39], a[188:191], v[88:91]
 ds_read_b128 a[176:179], v6 offset:10240
 v_mfma_f32_16x16x32_bf16 v[92:95], a[92:95], a[188:191], v[92:95]
 ds_read_b128 a[180:183], v7 offset:10240
 v_mfma_f32_16x16x32_bf16 v[92:95], a[88:91], a[184:187], v[92:95]
 v_mfma_f32_16x16x32_bf16 v[96:99], a[144:147], a[184:187], v[96:99]
 v_mfma_f32_16x16x32_bf16 v[96:99], a[148:151], a[188:191], v[96:99]
 v_mfma_f32_16x16x32_bf16 v[92:95], a[96:99], a[192:195], v[92:95]
 ds_read_b128 a[184:187], v6 offset:43008
 v_mfma_f32_16x16x32_bf16 v[92:95], a[100:103], a[196:199], v[92:95]
 s_waitcnt lgkmcnt(4)
 ds_read_b128 a[188:191], v7 offset:43008
 v_mfma_f32_16x16x32_bf16 v[92:95], a[104:107], a[168:171], v[92:95]
 v_mfma_f32_16x16x32_bf16 v[92:95], a[108:111], a[172:175], v[92:95]
 v_mfma_f32_16x16x32_bf16 v[88:91], a[52:55], a[172:175], v[88:91]
 v_mfma_f32_16x16x32_bf16 v[88:91], a[48:51], a[168:171], v[88:91]
 v_mfma_f32_16x16x32_bf16 v[88:91], a[44:47], a[196:199], v[88:91]
 v_mfma_f32_16x16x32_bf16 v[88:91], a[40:43], a[192:195], v[88:91]
 v_mfma_f32_16x16x32_bf16 v[96:99], a[152:155], a[192:195], v[96:99]
 v_mfma_f32_16x16x32_bf16 v[96:99], a[156:159], a[196:199], v[96:99]
 ds_read_b128 a[192:195], v6 offset:51200
 v_mfma_f32_16x16x32_bf16 v[96:99], a[160:163], a[168:171], v[96:99]
L_pad6:
 s_cbranch_execz L_hopdone1
 ds_read_b128 a[196:199], v7 offset:51200
 v_fma_f32 v28, v92, v16, v20
 v_mfma_f32_16x16x32_bf16 v[96:99], a[164:167], a[172:175], v[96:99]
 s_waitcnt lgkmcnt(3)
 v_fma_f32 v29, v93, v17, v21
 v_fma_f32 v30, v94, v18, v22
 v_mfma_f32_16x16x32_bf16 v[100:103], a[0:3], a[176:179], 0
 ds_read_b128 a[168:171], v6 offset:55296
 v_fma_f32 v31, v95, v19, v23
 v_mfma_f32_16x16x32_bf16 v[100:103], a[4:7], a[180:183], v[100:103]
 ds_read_b128 a[172:175], v7 offset:55296
 v_fmac_f32_dpp v28, v88, v16 row_shr:1 row_mask:0xf bank_mask:0xf bound_ctrl:0
 v_mfma_f32_16x16x32_bf16 v[104:107], a[60:63], a[180:183], 0
 v_fmac_f32_dpp v29, v89, v17 row_shr:1 row_mask:0xf bank_mask:0xf bound_ctrl:0
 v_fmac_f32_dpp v30, v90, v18 row_shr:1 row_mask:0xf bank_mask:0xf bound_ctrl:0
 v_mfma_f32_16x16x32_bf16 v[104:107], a[56:59], a[176:179], v[104:107]
 v_fmac_f32_dpp v31, v91, v19 row_shr:1 row_mask:0xf bank_mask:0xf bound_ctrl:0
 v_fmac_f32_dpp v28, v96, v16 row_shl:1 row_mask:0xf bank_mask:0xf bound_ctrl:0
 v_mfma_f32_16x16x32_bf16 v[108:111], a[112:115], a[176:179], 0
 v_fmac_f32_dpp v29, v97, v17 row_shl:1 row_mask:0xf bank_mask:0xf bound_ctrl:0
 v_fmac_f32_dpp v30, v98, v18 row_shl:1 row_mask:0xf bank_mask:0xf bound_ctrl:0
 v_mfma_f32_16x16x32_bf16 v[108:111], a[116:119], a[180:183], v[108:111]
 s_waitcnt lgkmcnt(3)
 v_fmac_f32_dpp v31, v99, v19 row_shl:1 row_mask:0xf bank_mask:0xf bound_ctrl:0
 v_mfma_f32_16x16x32_bf16 v[108:111], a[120:123], a[184:187], v[108:111]
 v_exp_f32 v36, v28
 v_mfma_f32_16x16x32_bf16 v[108:111], a[124:127], a[188:191], v[108:111]
 v_exp_f32 v37, v29
 v_mfma_f32_16x16x32_bf16 v[104:107], a[68:71], a[188:191], v[104:107]
 v_exp_f32 v38, v30
 v_mfma_f32_16x16x32_bf16 v[104:107], a[64:67], a[184:187], v[104:107]
 v_exp_f32 v39, v31
 v_mfma_f32_16x16x32_bf16 v[100:103], a[8:11], a[184:187], v[100:103]
 ds_read_b128 a[176:179], v6 offset:59392
 v_fma_f32 v36, v36, s53, s53
 v_mfma_f32_16x16x32_bf16 v[100:103], a[12:15], a[188:191], v[100:103]
 ds_read_b128 a[180:183], v7 offset:59392
 v_fma_f32 v37, v37, s53, s53
 v_mfma_f32_16x16x32_bf16 v[100:103], a[16:19], a[192:195], v[100:103]
 s_waitcnt lgkmcnt(2)
 ds_read_b128 a[184:187], v6 offset:63488
 v_fma_f32 v38, v38, s53, s53
 v_mfma_f32_16x16x32_bf16 v[100:103], a[20:23], a[196:199], v[100:103]
 ds_read_b128 a[188:191], v7 offset:63488
 v_fma_f32 v39, v39, s53, s53
 v_mfma_f32_16x16x32_bf16 v[104:107], a[76:79], a[196:199], v[104:107]
 v_rcp_f32 v36, v36
 v_mfma_f32_16x16x32_bf16 v[104:107], a[72:75], a[192:195], v[104:107]
 v_rcp_f32 v37, v37
 v_mfma_f32_16x16x32_bf16 v[108:111], a[128:131], a[192:195], v[108:111]
 v_rcp_f32 v38, v38
 v_mfma_f32_16x16x32_bf16 v[108:111], a[132:135], a[196:199], v[108:111]
 v_rcp_f32 v39, v39
 v_mfma_f32_16x16x32_bf16 v[108:111], a[136:139], a[168:171], v[108:111]
 ds_read_b128 a[192:195], v6 offset:47104
 v_mul_f32 v36, v36, v28
 v_mfma_f32_16x16x32_bf16 v[108:111], a[140:143], a[172:175], v[108:111]
 ds_read_b128 a[196:199], v7 offset:47104
 v_mul_f32 v37, v37, v29
 v_mfma_f32_16x16x32_bf16 v[104:107], a[84:87], a[172:175], v[104:107]
 s_waitcnt vmcnt(2)
 v_mul_f32 v38, v38, v30
 v_mul_f32 v39, v39, v31
 v_mfma_f32_16x16x32_bf16 v[104:107], a[80:83], a[168:171], v[104:107]
 s_barrier
 v_mfma_f32_16x16x32_bf16 v[100:103], a[24:27], a[168:171], v[100:103]
 ds_read_b128 v[48:51], v14 offset:0
 v_cvt_pk_bf16_f32 v44, v36, v37
 v_mfma_f32_16x16x32_bf16 v[100:103], a[28:31], a[172:175], v[100:103]
 s_waitcnt lgkmcnt(4)
 v_cvt_pk_bf16_f32 v45, v38, v39
 v_mfma_f32_16x16x32_bf16 v[100:103], a[32:35], a[176:179], v[100:103]
 s_add_u32 s61, s51, 344064
 ds_write_b64 v13, v[44:45] offset:4096
 v_mfma_f32_16x16x32_bf16 v[100:103], a[36:39], a[180:183], v[100:103]
 ds_read_b128 a[168:171], v8 offset:0
 v_mfma_f32_16x16x32_bf16 v[104:107], a[92:95], a[180:183], v[104:107]
 ds_read_b128 a[172:175], v9 offset:0
 v_mfma_f32_16x16x32_bf16 v[104:107], a[88:91], a[176:179], v[104:107]
 v_mfma_f32_16x16x32_bf16 v[108:111], a[144:147], a[176:179], v[108:111]
 s_waitcnt lgkmcnt(3)
 v_mfma_f32_16x16x32_bf16 v[108:111], a[148:151], a[180:183], v[108:111]
 buffer_store_dwordx4 v[48:51], v3, s[28:31], s61 offen sc1
 v_mfma_f32_16x16x32_bf16 v[104:107], a[96:99], a[184:187], v[104:107]
 ds_read_b128 a[176:179], v8 offset:2048
 v_mfma_f32_16x16x32_bf16 v[104:107], a[100:103], a[188:191], v[104:107]
 ds_read_b128 a[180:183], v9 offset:2048
 v_mfma_f32_16x16x32_bf16 v[104:107], a[104:107], a[192:195], v[104:107]
 v_mfma_f32_16x16x32_bf16 v[104:107], a[108:111], a[196:199], v[104:107]
 v_mfma_f32_16x16x32_bf16 v[100:103], a[52:55], a[196:199], v[100:103]
 v_mfma_f32_16x16x32_bf16 v[100:103], a[48:51], a[192:195], v[100:103]
 v_mfma_f32_16x16x32_bf16 v[100:103], a[44:47], a[188:191], v[100:103]
 v_mfma_f32_16x16x32_bf16 v[100:103], a[40:43], a[184:187], v[100:103]
 v_mfma_f32_16x16x32_bf16 v[108:111], a[152:155], a[184:187], v[108:111]
 v_mfma_f32_16x16x32_bf16 v[108:111], a[156:159], a[188:191], v[108:111]
 ds_read_b128 a[184:187], v8 offset:4096
 v_mfma_f32_16x16x32_bf16 v[108:111], a[160:163], a[192:195], v[108:111]
 ds_read_b128 a[188:191], v9 offset:4096
 v_fma_f32 v32, v104, v16, v20
 v_mfma_f32_16x16x32_bf16 v[108:111], a[164:167], a[196:199], v[108:111]
 s_cmp_lg_u32 s43, 0
 s_cbranch_scc1 L_exit0
 s_waitcnt lgkmcnt(3)
 v_mfma_f32_16x16x32_bf16 v[112:115], a[0:3], a[168:171], 0
 ds_read_b128 a[192:195], v8 offset:6144
 v_fma_f32 v33, v105, v17, v21
 v_mfma_f32_16x16x32_bf16 v[112:115], a[4:7], a[172:175], v[112:115]
 ds_read_b128 a[196:199], v9 offset:6144
 v_fma_f32 v34, v106, v18, v22
 v_mfma_f32_16x16x32_bf16 v[116:119], a[60:63], a[172:175], 0
 v_fma_f32 v35, v107, v19, v23
 v_fmac_f32_dpp v32, v100, v16 row_shr:1 row_mask:0xf bank_mask:0xf bound_ctrl:0
 v_mfma_f32_16x16x32_bf16 v[116:119], a[56:59], a[168:171], v[116:119]
 v_fmac_f32_dpp v33, v101, v17 row_shr:1 row_mask:0xf bank_mask:0xf bound_ctrl:0
 v_fmac_f32_dpp v34, v102, v18 row_shr:1 row_mask:0xf bank_mask:0xf bound_ctrl:0
 v_mfma_f32_16x16x32_bf16 v[120:123], a[112:115], a[168:171], 0
 v_fmac_f32_dpp v35, v103, v19 row_shr:1 row_mask:0xf bank_mask:0xf bound_ctrl:0
 v_fmac_f32_dpp v32, v108, v16 row_shl:1 row_mask:0xf bank_mask:0xf bound_ctrl:0
 v_mfma_f32_16x16x32_bf16 v[120:123], a[116:119], a[172:175], v[120:123]
 v_fmac_f32_dpp v33, v109, v17 row_shl:1 row_mask:0xf bank_mask:0xf bound_ctrl:0
 v_fmac_f32_dpp v34, v110, v18 row_shl:1 row_mask:0xf bank_mask:0xf bound_ctrl:0
 v_mfma_f32_16x16x32_bf16 v[120:123], a[120:123], a[176:179], v[120:123]
 s_waitcnt lgkmcnt(2)
 ds_read_b128 a[168:171], v8 offset:12288
 v_fmac_f32_dpp v35, v111, v19 row_shl:1 row_mask:0xf bank_mask:0xf bound_ctrl:0
 v_mfma_f32_16x16x32_bf16 v[120:123], a[124:127], a[180:183], v[120:123]
 v_exp_f32 v40, v32
 v_mfma_f32_16x16x32_bf16 v[116:119], a[68:71], a[180:183], v[116:119]
 v_exp_f32 v41, v33
 v_mfma_f32_16x16x32_bf16 v[116:119], a[64:67], a[176:179], v[116:119]
 v_exp_f32 v42, v34
 v_mfma_f32_16x16x32_bf16 v[112:115], a[8:11], a[176:179], v[112:115]
 v_exp_f32 v43, v35
 v_mfma_f32_16x16x32_bf16 v[112:115], a[12:15], a[180:183], v[112:115]
 ds_read_b128 a[172:175], v9 offset:12288
 v_fma_f32 v40, v40, s53, s53
 v_mfma_f32_16x16x32_bf16 v[112:115], a[16:19], a[184:187], v[112:115]
 ds_read_b128 a[176:179], v8 offset:14336
 v_fma_f32 v41, v41, s53, s53
 v_mfma_f32_16x16x32_bf16 v[112:115], a[20:23], a[188:191], v[112:115]
 ds_read_b128 a[180:183], v9 offset:14336
 v_fma_f32 v42, v42, s53, s53
 v_mfma_f32_16x16x32_bf16 v[116:119], a[76:79], a[188:191], v[116:119]
 v_fma_f32 v43, v43, s53, s53
 v_mfma_f32_16x16x32_bf16 v[116:119], a[72:75], a[184:187], v[116:119]
 v_rcp_f32 v40, v40
 v_mfma_f32_16x16x32_bf16 v[120:123], a[128:131], a[184:187], v[120:123]
 v_rcp_f32 v41, v41
 v_mfma_f32_16x16x32_bf16 v[120:123], a[132:135], a[188:191], v[120:123]
 s_waitcnt lgkmcnt(3)
 v_rcp_f32 v42, v42
 v_mfma_f32_16x16x32_bf16 v[120:123], a[136:139], a[192:195], v[120:123]
 v_rcp_f32 v43, v43
 v_mfma_f32_16x16x32_bf16 v[120:123], a[140:143], a[196:199], v[120:123]
 ds_read_b128 a[184:187], v4 offset:0
 v_mul_f32 v40, v40, v32
 v_mfma_f32_16x16x32_bf16 v[116:119], a[84:87], a[196:199], v[116:119]
 ds_read_b128 a[188:191], v5 offset:0
 v_mul_f32 v41, v41, v33
 v_mfma_f32_16x16x32_bf16 v[116:119], a[80:83], a[192:195], v[116:119]
 v_mul_f32 v42, v42, v34
 v_mul_f32 v43, v43, v35
 v_mfma_f32_16x16x32_bf16 v[112:115], a[24:27], a[192:195], v[112:115]
 v_cvt_pk_bf16_f32 v46, v40, v41
 v_cvt_pk_bf16_f32 v47, v42, v43
 v_mfma_f32_16x16x32_bf16 v[112:115], a[28:31], a[196:199], v[112:115]
 s_waitcnt lgkmcnt(3)
 ds_write_b64 v13, v[46:47] offset:6144
 v_mfma_f32_16x16x32_bf16 v[112:115], a[32:35], a[168:171], v[112:115]
 v_mfma_f32_16x16x32_bf16 v[112:115], a[36:39], a[172:175], v[112:115]
 v_mfma_f32_16x16x32_bf16 v[116:119], a[92:95], a[172:175], v[116:119]
 v_mfma_f32_16x16x32_bf16 v[116:119], a[88:91], a[168:171], v[116:119]
 v_mfma_f32_16x16x32_bf16 v[120:123], a[144:147], a[168:171], v[120:123]
 s_waitcnt lgkmcnt(0)
 v_mfma_f32_16x16x32_bf16 v[120:123], a[148:151], a[172:175], v[120:123]
 s_barrier
 v_mfma_f32_16x16x32_bf16 v[116:119], a[96:99], a[176:179], v[116:119]
 ds_read_b128 v[52:55], v14 offset:4096
 v_mfma_f32_16x16x32_bf16 v[116:119], a[100:103], a[180:183], v[116:119]
 s_add_u32 s61, s51, 372736
 v_mfma_f32_16x16x32_bf16 v[116:119], a[104:107], a[184:187], v[116:119]
 v_mfma_f32_16x16x32_bf16 v[116:119], a[108:111], a[188:191], v[116:119]
 v_mfma_f32_16x16x32_bf16 v[112:115], a[52:55], a[188:191], v[112:115]
 v_mfma_f32_16x16x32_bf16 v[112:115], a[48:51], a[184:187], v[112:115]
 v_mfma_f32_16x16x32_bf16 v[112:115], a[44:47], a[180:183], v[112:115]
 s_waitcnt lgkmcnt(0)
 v_mfma_f32_16x16x32_bf16 v[112:115], a[40:43], a[176:179], v[112:115]
 buffer_store_dwordx4 v[52:55], v3, s[28:31], s61 offen sc1
 v_mfma_f32_16x16x32_bf16 v[120:123], a[152:155], a[176:179], v[120:123]
 v_mfma_f32_16x16x32_bf16 v[120:123], a[156:159], a[180:183], v[120:123]
 v_fma_f32 v28, v116, v16, v20
 v_fma_f32 v29, v117, v17, v21
 v_mfma_f32_16x16x32_bf16 v[120:123], a[160:163], a[184:187], v[120:123]
 v_fma_f32 v30, v118, v18, v22
 v_fma_f32 v31, v119, v19, v23
 v_mfma_f32_16x16x32_bf16 v[120:123], a[164:167], a[188:191], v[120:123]
 v_fmac_f32_dpp v28, v112, v16 row_shr:1 row_mask:0xf bank_mask:0xf bound_ctrl:0
 v_fmac_f32_dpp v29, v113, v17 row_shr:1 row_mask:0xf bank_mask:0xf bound_ctrl:0
 v_fmac_f32_dpp v30, v114, v18 row_shr:1 row_mask:0xf bank_mask:0xf bound_ctrl:0
 v_fmac_f32_dpp v31, v115, v19 row_shr:1 row_mask:0xf bank_mask:0xf bound_ctrl:0
 s_nop 0
 s_nop 0
 s_nop 0
 s_nop 0
 v_fmac_f32_dpp v28, v120, v16 row_shl:1 row_mask:0xf bank_mask:0xf bound_ctrl:0
 v_fmac_f32_dpp v29, v121, v17 row_shl:1 row_mask:0xf bank_mask:0xf bound_ctrl:0
 v_fmac_f32_dpp v30, v122, v18 row_shl:1 row_mask:0xf bank_mask:0xf bound_ctrl:0
 v_fmac_f32_dpp v31, v123, v19 row_shl:1 row_mask:0xf bank_mask:0xf bound_ctrl:0
 v_exp_f32 v36, v28
 v_exp_f32 v37, v29
 v_exp_f32 v38, v30
 v_exp_f32 v39, v31
 v_fma_f32 v36, v36, s53, s53
 v_fma_f32 v37, v37, s53, s53
 v_fma_f32 v38, v38, s53, s53
 v_fma_f32 v39, v39, s53, s53
 v_rcp_f32 v36, v36
 v_rcp_f32 v37, v37
 v_rcp_f32 v38, v38
 v_rcp_f32 v39, v39
 v_mul_f32 v36, v36, v28
 v_mul_f32 v37, v37, v29
 v_mul_f32 v38, v38, v30
 v_mul_f32 v39, v39, v31
 v_cvt_pk_bf16_f32 v44, v36, v37
 v_cvt_pk_bf16_f32 v45, v38, v39
 ds_write_b64 v13, v[44:45] offset:8192
 s_waitcnt lgkmcnt(0)
 s_barrier
 ds_read_b128 v[48:51], v14 offset:8192
 s_add_u32 s61, s56, 401408
 s_waitcnt lgkmcnt(0)
 buffer_store_dwordx4 v[48:51], v3, s[28:31], s61 offen sc1
 s_endpgm
L_exit0:
L_pad7:
 s_cbranch_execz L_hopdone1
 v_fma_f32 v33, v105, v17, v21
 v_fma_f32 v34, v106, v18, v22
 v_fma_f32 v35, v107, v19, v23
 v_fmac_f32_dpp v32, v100, v16 row_shr:1 row_mask:0xf bank_mask:0xf bound_ctrl:0
 v_fmac_f32_dpp v33, v101, v17 row_shr:1 row_mask:0xf bank_mask:0xf bound_ctrl:0
 v_fmac_f32_dpp v34, v102, v18 row_shr:1 row_mask:0xf bank_mask:0xf bound_ctrl:0
 v_fmac_f32_dpp v35, v103, v19 row_shr:1 row_mask:0xf bank_mask:0xf bound_ctrl:0
 v_fmac_f32_dpp v32, v108, v16 row_shl:1 row_mask:0xf bank_mask:0xf bound_ctrl:0
 v_fmac_f32_dpp v33, v109, v17 row_shl:1 row_mask:0xf bank_mask:0xf bound_ctrl:0
 v_fmac_f32_dpp v34, v110, v18 row_shl:1 row_mask:0xf bank_mask:0xf bound_ctrl:0
 v_fmac_f32_dpp v35, v111, v19 row_shl:1 row_mask:0xf bank_mask:0xf bound_ctrl:0
 v_exp_f32 v40, v32
 v_exp_f32 v41, v33
 v_exp_f32 v42, v34
 v_exp_f32 v43, v35
 v_fma_f32 v40, v40, s53, s53
 v_fma_f32 v41, v41, s53, s53
 v_fma_f32 v42, v42, s53, s53
 v_fma_f32 v43, v43, s53, s53
 v_rcp_f32 v40, v40
 v_rcp_f32 v41, v41
 v_rcp_f32 v42, v42
 v_rcp_f32 v43, v43
 v_mul_f32 v40, v40, v32
 v_mul_f32 v41, v41, v33
 v_mul_f32 v42, v42, v34
 v_mul_f32 v43, v43, v35
 v_cvt_pk_bf16_f32 v46, v40, v41
 v_cvt_pk_bf16_f32 v47, v42, v43
 ds_write_b64 v13, v[46:47] offset:6144
 s_waitcnt lgkmcnt(0)
 s_barrier
 ds_read_b128 v[52:55], v14 offset:4096
 s_add_u32 s61, s51, 372736
 s_waitcnt lgkmcnt(0)
 buffer_store_dwordx4 v[52:55], v3, s[28:31], s61 offen sc1
 s_endpgm
L_fin:
L_end:
    s_endpgm
.section .rodata,"a"
.p2align 6
.amdhsa_kernel standalone__batchnorm__sampling_kernel
  .amdhsa_next_free_vgpr 512
  .amdhsa_next_free_sgpr 102
  .amdhsa_accum_offset 256
  .amdhsa_group_segment_fixed_size 0
  .amdhsa_kernarg_size 72
  .amdhsa_user_sgpr_count 2
  .amdhsa_user_sgpr_kernarg_segment_ptr 1
  .amdhsa_system_sgpr_workgroup_id_x 1
.end_amdhsa_kernel
```
